```python
import torch

def _softmax(x, axis=-1):
    return torch.softmax(x, dim=axis)

def _gelu(x):
    return torch.nn.functional.gelu(x, approximate='tanh')

def _silu(x):
    return torch.nn.functional.silu(x)

def _sigmoid(x):
    return torch.sigmoid(x)

def _layernorm(x, axis=-1, eps=1e-05):
    m = x.mean(dim=axis, keepdim=True)
    v = x.var(dim=axis, keepdim=True, unbiased=False)
    return (x - m) / torch.sqrt(v + eps)

def _scatter_add(tgt, idx, src, axis=0):
    return tgt.clone().index_add_(axis, idx, src)

def _segment_sum(src, seg, n):
    out = torch.zeros((n,) + src.shape[1:], dtype=src.dtype)
    return out.index_add_(0, seg, src)

def _pad(x, pw):
    flat = tuple((v for pair in reversed(pw) for v in pair))
    return torch.nn.functional.pad(x, flat)
kernel_name = 'adaLN_cond__sliding_block_cached__swiglu_ffn__decode'

def setup_inputs():

    _w = lambda a: (lambda t: t.to(torch.bfloat16) if t.is_floating_point() else t)(torch.as_tensor(a))

    def _A_setup():
        B, Sq, D = (4, 1, 512)
        Hq, Hkv, Sk, Dh = (32, 8, 8192, 128)
        assert Hq % Hkv == 0, (Hq, Hkv)
        return {'x': _w((lambda *s: torch.randn(*s, dtype=torch.bfloat16) * 0.05)(B, Sq, D)), 'k_cache': _w((lambda *s: torch.randn(*s, dtype=torch.bfloat16) * 3.2)(B, Hkv, Sk, Dh)), 'v_cache': _w((lambda *s: torch.randn(*s, dtype=torch.bfloat16) * 0.4)(B, Hkv, Sk, Dh)), 'wq': _w((lambda *s: torch.randn(*s, dtype=torch.bfloat16) * 3.2)(D, Hq * Dh) * D ** (-0.5)), 'wo': _w((lambda *s: torch.randn(*s, dtype=torch.bfloat16) * 0.4)(Hq * Dh, D) * (Hq * Dh) ** (-0.5))}
    _A_in = _A_setup()

    def _B_setup():
        B, S, D, F = (4, 1, 512, 1792)
        return {'x': _w((lambda *s: torch.randn(*s, dtype=torch.bfloat16) * 0.05)(B, S, D)), 'w_gate': _w((lambda *s: torch.randn(*s, dtype=torch.bfloat16) * 0.05)(D, F)), 'w_up': _w((lambda *s: torch.randn(*s, dtype=torch.bfloat16) * 0.05)(D, F)), 'w_down': _w((lambda *s: torch.randn(*s, dtype=torch.bfloat16) * 0.05)(F, D))}
    _B_in = _B_setup()
    return {'A_x': _A_in['x'], 'A_k_cache': _A_in['k_cache'], 'A_v_cache': _A_in['v_cache'], 'A_wq': _A_in['wq'], 'A_wo': _A_in['wo'], 'B_x': _B_in['x'], 'B_w_gate': _B_in['w_gate'], 'B_w_up': _B_in['w_up'], 'B_w_down': _B_in['w_down'], 'c': _w((lambda *s: torch.randn(*s, dtype=torch.bfloat16) * 0.1)(4, 512) * 8.0), 'w_mod': _w((lambda *s: torch.randn(*s, dtype=torch.bfloat16) * 0.1)(512, 6 * 512) * 512 ** (-0.5) * 8.0)}

def reference(A_x, A_k_cache, A_v_cache, A_wq, A_wo, B_x, B_w_gate, B_w_up, B_w_down, c, w_mod):

    def _A_ref(x, k_cache, v_cache, wq, wo):
        B, Sq, D = x.shape
        Hq, Dh = (32, 128)
        Hkv, Sk = (k_cache.shape[1], k_cache.shape[2])
        W = min(4096, max(256, Sk // 4))
        rep = Hq // Hkv
        q = (lambda x, *d: x.permute(*d))((x @ wq).reshape(B, Sq, Hq, Dh), 0, 2, 1, 3)
        k = (lambda x, n, axis: torch.repeat_interleave(x, n, dim=axis))(k_cache[:, :, Sk - W:, :], rep, axis=1)
        v = (lambda x, n, axis: torch.repeat_interleave(x, n, dim=axis))(v_cache[:, :, Sk - W:, :], rep, axis=1)
        scores = torch.einsum('bhqd,bhkd->bhqk', q, k) * Dh ** (-0.5)
        p = _softmax(scores, axis=-1)
        o = torch.einsum('bhqk,bhkd->bhqd', p, v)
        return (lambda x, *d: x.permute(*d))(o, 0, 2, 1, 3).reshape(B, Sq, Hq * Dh) @ wo

    def _B_ref(x, w_gate, w_up, w_down):
        g = _silu(x @ w_gate)
        u = x @ w_up
        return g * u @ w_down
    x = A_x
    mod = (_silu(c) @ w_mod).reshape(c.shape[0], 6, 1, -1)
    sa, ca, ga, sb, cb, gb = (mod[:, 0].clone(), mod[:, 1].clone(), mod[:, 2].clone(), mod[:, 3].clone(), mod[:, 4].clone(), mod[:, 5].clone())
    h = _layernorm(x, axis=-1) * (1 + ca) + sa
    x = x + ga * _A_ref(h, A_k_cache, A_v_cache, A_wq, A_wo)
    h = _layernorm(x, axis=-1) * (1 + cb) + sb
    x = x + gb * _B_ref(h, B_w_gate, B_w_up, B_w_down)
    return x
```

```asm
; @launch grid=(256,1,1) block=(768,1,1) lds=20480
.amdgcn_target "amdgcn-amd-amdhsa--gfx950"
.text
.globl adaLN_cond__sliding_block_cached__swiglu_ffn__decode_kernel
.p2align 8
.type adaLN_cond__sliding_block_cached__swiglu_ffn__decode_kernel,@function
adaLN_cond__sliding_block_cached__swiglu_ffn__decode_kernel:
    s_load_dwordx16 s[32:47], s[0:1], 0
    s_load_dwordx8 s[48:55], s[0:1], 64
    s_load_dwordx4 s[56:59], s[0:1], 96
    s_cmp_ge_u32 s2, 256
    s_cbranch_scc1 L_END
    v_lshrrev_b32 v1, 6, v0
    v_and_b32 v0, 63, v0
    v_readfirstlane_b32 s23, v1
    s_and_b32 s16, s2, 7
    s_lshr_b32 s17, s2, 3
    s_lshr_b32 s19, s17, 3
    s_and_b32 s20, s17, 7
    s_and_b32 s21, s23, 3
    s_cmp_lt_u32 s23, 8
    s_cbranch_scc1 L_KV
    s_setprio 3
    v_lshrrev_b32 v8, 4, v0
    v_bfe_u32 v9, v0, 3, 1
    v_lshlrev_b32 v8, 4, v8
    v_lshlrev_b32 v9, 3, v9
    v_add_u32 v8, v8, v9
    s_mov_b32 s24, 6144
    v_mul_lo_u32 v8, v8, s24
    v_and_b32 v9, 7, v0
    v_lshlrev_b32 v9, 4, v9
    v_add_u32 v2, v8, v9
    v_bfe_u32 v8, v0, 1, 2
    v_lshrrev_b32 v9, 4, v0
    v_lshlrev_b32 v9, 1, v9
    v_and_b32 v1, 1, v0
    v_add_u32 v9, v9, v1
    v_lshlrev_b32 v8, 10, v8
    v_lshlrev_b32 v9, 4, v9
    v_add_u32 v10, v8, v9
    s_sub_u32 s24, s17, 8
    s_cmp_lt_u32 s17, 4
    s_cselect_b32 s24, s17, s24
    s_lshl_b32 s25, s16, 3
    s_add_u32 s25, s25, s24
    s_sub_u32 s26, s16, 4
    s_lshl_b32 s26, s26, 4
    s_add_u32 s26, s26, s24
    s_add_u32 s26, s26, 32
    s_cmp_lt_u32 s16, 4
    s_cselect_b32 s25, s25, s26
    s_lshr_b32 s61, s25, 1
    s_and_b32 s62, s25, 1
    s_lshl_b32 s24, s62, 2
    s_add_u32 s24, s24, s21
    s_mul_i32 s28, s24, 393216
    s_lshl_b32 s25, s61, 7
    s_add_u32 s28, s28, s25
    s_lshl_b32 s29, s62, 9
    s_lshl_b32 s25, s21, 7
    s_add_u32 s29, s29, s25
    s_cmp_lt_u32 s16, 4
    s_cselect_b32 s26, 4, 12
    s_sub_u32 s24, s17, 12
    s_cmp_lt_u32 s24, s26
    s_cselect_b32 s63, 1, 0
    s_cmp_lt_u32 s17, 4
    s_cselect_b32 s63, 1, s63
    s_sub_u32 s85, s17, 4
    s_waitcnt lgkmcnt(0)
    s_load_dword s60, s[58:59], 0
    s_cmp_eq_u32 s63, 0
    s_cbranch_scc1 nm_1
    s_mov_b32 s8, s52
    s_mov_b32 s9, s53
    s_add_u32 s8, s8, s28
    s_addc_u32 s9, s9, 0
    s_and_b32 s9, s9, 0xffff
    s_mov_b32 s10, 387200
    s_mov_b32 s11, 0x00020000
    s_mov_b32 s12, s50
    s_mov_b32 s13, s51
    s_and_b32 s13, s13, 0xffff
    s_mov_b32 s14, 4096
    s_mov_b32 s15, 0x00020000
    buffer_load_dwordx4 v[4:7], v10, s[12:15], s29 offen
    buffer_load_dwordx4 v[32:35], v2, s[8:11], 0 offen offset:0 nt
    s_mov_b32 s84, 6144
    buffer_load_dwordx4 v[36:39], v2, s[8:11], s84 offen nt
    s_mov_b32 s84, 12288
    buffer_load_dwordx4 v[40:43], v2, s[8:11], s84 offen nt
    s_mov_b32 s84, 18432
    buffer_load_dwordx4 v[44:47], v2, s[8:11], s84 offen nt
    s_mov_b32 s84, 24576
    buffer_load_dwordx4 v[48:51], v2, s[8:11], s84 offen nt
    s_mov_b32 s84, 30720
    buffer_load_dwordx4 v[52:55], v2, s[8:11], s84 offen nt
    s_mov_b32 s84, 36864
    buffer_load_dwordx4 v[56:59], v2, s[8:11], s84 offen nt
    s_mov_b32 s84, 43008
    buffer_load_dwordx4 v[60:63], v2, s[8:11], s84 offen nt
nm_1:
    s_cmp_lt_u32 s85, 8
    s_cbranch_scc0 nq_2
    v_lshrrev_b32 v8, 4, v0
    v_bfe_u32 v9, v0, 3, 1
    v_lshlrev_b32 v8, 4, v8
    v_lshlrev_b32 v9, 3, v9
    v_add_u32 v8, v8, v9
    s_mov_b32 s24, 8192
    v_mul_lo_u32 v8, v8, s24
    v_and_b32 v9, 7, v0
    v_lshlrev_b32 v9, 4, v9
    v_add_u32 v3, v8, v9
    s_lshl_b32 s30, s21, 20
    s_lshl_b32 s25, s16, 10
    s_add_u32 s30, s30, s25
    s_lshl_b32 s25, s85, 7
    s_add_u32 s30, s30, s25
    s_mov_b32 s8, s38
    s_mov_b32 s9, s39
    s_add_u32 s8, s8, s30
    s_addc_u32 s9, s9, 0
    s_and_b32 s9, s9, 0xffff
    s_mov_b32 s10, 1040512
    s_mov_b32 s11, 0x00020000
    buffer_load_dwordx4 v[64:67], v3, s[8:11], 0 offen offset:0 nt
    s_mov_b32 s84, 8192
    buffer_load_dwordx4 v[68:71], v3, s[8:11], s84 offen nt
    s_mov_b32 s84, 16384
    buffer_load_dwordx4 v[72:75], v3, s[8:11], s84 offen nt
    s_mov_b32 s84, 24576
    buffer_load_dwordx4 v[76:79], v3, s[8:11], s84 offen nt
    s_mov_b32 s84, 32768
    buffer_load_dwordx4 v[80:83], v3, s[8:11], s84 offen nt
    s_mov_b32 s84, 40960
    buffer_load_dwordx4 v[84:87], v3, s[8:11], s84 offen nt
    s_mov_b32 s84, 49152
    buffer_load_dwordx4 v[88:91], v3, s[8:11], s84 offen nt
    s_mov_b32 s84, 57344
    buffer_load_dwordx4 v[92:95], v3, s[8:11], s84 offen nt
    s_mov_b32 s84, 524288
    buffer_load_dwordx4 v[96:99], v3, s[8:11], s84 offen nt
    s_mov_b32 s84, 532480
    buffer_load_dwordx4 v[100:103], v3, s[8:11], s84 offen nt
    s_mov_b32 s84, 540672
    buffer_load_dwordx4 v[104:107], v3, s[8:11], s84 offen nt
    s_mov_b32 s84, 548864
    buffer_load_dwordx4 v[108:111], v3, s[8:11], s84 offen nt
    s_mov_b32 s84, 557056
    buffer_load_dwordx4 v[112:115], v3, s[8:11], s84 offen nt
    s_mov_b32 s84, 565248
    buffer_load_dwordx4 v[116:119], v3, s[8:11], s84 offen nt
    s_mov_b32 s84, 573440
    buffer_load_dwordx4 v[120:123], v3, s[8:11], s84 offen nt
    s_mov_b32 s84, 581632
    buffer_load_dwordx4 v[124:127], v3, s[8:11], s84 offen nt
nq_2:
    s_barrier
    s_branch L_CHAIN2
L_KV:
    s_nop 3
    s_mul_i32 s27, s21, 5
    s_add_u32 s27, s27, s17
    s_mul_i32 s26, s16, 3
    s_add_u32 s27, s27, s26
    s_and_b32 s27, s27, 15
    s_lshl_b32 s27, s27, 10
    s_mov_b32 s80, 0x20000
    s_cmp_ge_u32 s23, 4
    s_cbranch_scc1 L_VROLE
    v_bfe_u32 v1, v0, 2, 2
    v_lshlrev_b32 v1, 8, v1
    v_lshrrev_b32 v2, 4, v0
    v_lshlrev_b32 v2, 6, v2
    v_add_u32 v1, v1, v2
    v_and_b32 v2, 3, v0
    v_lshlrev_b32 v2, 4, v2
    v_add_u32 v3, v1, v2
    s_barrier
    s_waitcnt lgkmcnt(0)
    s_lshl_b32 s24, s19, 3
    s_add_u32 s24, s24, s16
    s_lshl_b32 s24, s24, 21
    s_lshl_b32 s25, s20, 16
    s_add_u32 s24, s24, s25
    s_lshl_b32 s25, s21, 14
    s_add_u32 s24, s24, s25
    s_mov_b32 s8, s34
    s_mov_b32 s9, s35
    s_add_u32 s8, s8, s24
    s_addc_u32 s9, s9, 0
    s_add_u32 s8, s8, 1572864
    s_addc_u32 s9, s9, 0
    s_and_b32 s9, s9, 0xffff
    s_mov_b32 s10, 16384
    s_mov_b32 s11, 0x00020000
    s_sub_u32 s85, s17, 4
    s_cmp_lt_u32 s85, 8
    s_cbranch_scc1 k3_4
    s_cmp_lt_u32 s16, 4
    s_cbranch_scc0 k2_3
    s_cmp_lt_u32 s17, 16
    s_cbranch_scc0 k2_3
    v_mov_b32 v1, 0
spin_6:
    ds_read_b32 v2, v1 offset:76
    s_waitcnt lgkmcnt(0)
    v_readfirstlane_b32 s24, v2
    s_nop 0
    s_cmp_ge_u32 s24, 4
    s_cbranch_scc1 spun_7
    s_cmp_eq_u32 s80, 0
    s_cbranch_scc1 spun_7
    s_sub_u32 s80, s80, 1
    s_sleep 1
    s_branch spin_6
spun_7:
k2_3:
    s_cmp_lt_u32 s16, 4
    s_cselect_b32 s25, 4, 12
    s_sub_u32 s24, s17, 12
    s_cmp_lt_u32 s24, s25
    s_cselect_b32 s25, 1, 0
    s_cmp_lt_u32 s17, 4
    s_cselect_b32 s25, 1, s25
    s_cmp_eq_u32 s25, 1
    s_cbranch_scc1 k5_8
    buffer_load_dwordx4 v[64:67], v3, s[8:11], s27 offen nt
    s_add_u32 s27, s27, 1024
    s_and_b32 s27, s27, 0x3fff
    buffer_load_dwordx4 v[68:71], v3, s[8:11], s27 offen nt
    s_add_u32 s27, s27, 1024
    s_and_b32 s27, s27, 0x3fff
    buffer_load_dwordx4 v[72:75], v3, s[8:11], s27 offen nt
    s_add_u32 s27, s27, 1024
    s_and_b32 s27, s27, 0x3fff
    s_waitcnt vmcnt(2)
    buffer_load_dwordx4 v[76:79], v3, s[8:11], s27 offen nt
    s_add_u32 s27, s27, 1024
    s_and_b32 s27, s27, 0x3fff
    s_waitcnt vmcnt(2)
    buffer_load_dwordx4 v[80:83], v3, s[8:11], s27 offen nt
    s_add_u32 s27, s27, 1024
    s_and_b32 s27, s27, 0x3fff
    s_waitcnt vmcnt(2)
    buffer_load_dwordx4 v[84:87], v3, s[8:11], s27 offen nt
    s_add_u32 s27, s27, 1024
    s_and_b32 s27, s27, 0x3fff
    s_waitcnt vmcnt(2)
    buffer_load_dwordx4 v[88:91], v3, s[8:11], s27 offen nt
    s_add_u32 s27, s27, 1024
    s_and_b32 s27, s27, 0x3fff
    s_waitcnt vmcnt(2)
    buffer_load_dwordx4 v[92:95], v3, s[8:11], s27 offen nt
    s_add_u32 s27, s27, 1024
    s_and_b32 s27, s27, 0x3fff
    s_waitcnt vmcnt(2)
    buffer_load_dwordx4 v[96:99], v3, s[8:11], s27 offen nt
    s_add_u32 s27, s27, 1024
    s_and_b32 s27, s27, 0x3fff
    s_waitcnt vmcnt(2)
    buffer_load_dwordx4 v[100:103], v3, s[8:11], s27 offen nt
    s_add_u32 s27, s27, 1024
    s_and_b32 s27, s27, 0x3fff
    s_waitcnt vmcnt(2)
    buffer_load_dwordx4 v[104:107], v3, s[8:11], s27 offen nt
    s_add_u32 s27, s27, 1024
    s_and_b32 s27, s27, 0x3fff
    s_waitcnt vmcnt(2)
    buffer_load_dwordx4 v[108:111], v3, s[8:11], s27 offen nt
    s_add_u32 s27, s27, 1024
    s_and_b32 s27, s27, 0x3fff
    s_waitcnt vmcnt(2)
    buffer_load_dwordx4 v[112:115], v3, s[8:11], s27 offen nt
    s_add_u32 s27, s27, 1024
    s_and_b32 s27, s27, 0x3fff
    s_waitcnt vmcnt(2)
    buffer_load_dwordx4 v[116:119], v3, s[8:11], s27 offen nt
    s_add_u32 s27, s27, 1024
    s_and_b32 s27, s27, 0x3fff
    s_waitcnt vmcnt(2)
    buffer_load_dwordx4 v[120:123], v3, s[8:11], s27 offen nt
    s_add_u32 s27, s27, 1024
    s_and_b32 s27, s27, 0x3fff
    s_waitcnt vmcnt(2)
    buffer_load_dwordx4 v[124:127], v3, s[8:11], s27 offen nt
    s_branch k4_5
k5_8:
    buffer_load_dwordx4 v[64:67], v3, s[8:11], s27 offen nt
    s_add_u32 s27, s27, 1024
    s_and_b32 s27, s27, 0x3fff
    buffer_load_dwordx4 v[68:71], v3, s[8:11], s27 offen nt
    s_add_u32 s27, s27, 1024
    s_and_b32 s27, s27, 0x3fff
    buffer_load_dwordx4 v[72:75], v3, s[8:11], s27 offen nt
    s_add_u32 s27, s27, 1024
    s_and_b32 s27, s27, 0x3fff
    buffer_load_dwordx4 v[76:79], v3, s[8:11], s27 offen nt
    s_add_u32 s27, s27, 1024
    s_and_b32 s27, s27, 0x3fff
    buffer_load_dwordx4 v[80:83], v3, s[8:11], s27 offen nt
    s_add_u32 s27, s27, 1024
    s_and_b32 s27, s27, 0x3fff
    buffer_load_dwordx4 v[84:87], v3, s[8:11], s27 offen nt
    s_add_u32 s27, s27, 1024
    s_and_b32 s27, s27, 0x3fff
    s_waitcnt vmcnt(5)
    buffer_load_dwordx4 v[88:91], v3, s[8:11], s27 offen nt
    s_add_u32 s27, s27, 1024
    s_and_b32 s27, s27, 0x3fff
    s_waitcnt vmcnt(5)
    buffer_load_dwordx4 v[92:95], v3, s[8:11], s27 offen nt
    s_add_u32 s27, s27, 1024
    s_and_b32 s27, s27, 0x3fff
    s_waitcnt vmcnt(5)
    buffer_load_dwordx4 v[96:99], v3, s[8:11], s27 offen nt
    s_add_u32 s27, s27, 1024
    s_and_b32 s27, s27, 0x3fff
    s_waitcnt vmcnt(5)
    buffer_load_dwordx4 v[100:103], v3, s[8:11], s27 offen nt
    s_add_u32 s27, s27, 1024
    s_and_b32 s27, s27, 0x3fff
    s_waitcnt vmcnt(5)
    buffer_load_dwordx4 v[104:107], v3, s[8:11], s27 offen nt
    s_add_u32 s27, s27, 1024
    s_and_b32 s27, s27, 0x3fff
    s_waitcnt vmcnt(5)
    buffer_load_dwordx4 v[108:111], v3, s[8:11], s27 offen nt
    s_add_u32 s27, s27, 1024
    s_and_b32 s27, s27, 0x3fff
    s_waitcnt vmcnt(5)
    buffer_load_dwordx4 v[112:115], v3, s[8:11], s27 offen nt
    s_add_u32 s27, s27, 1024
    s_and_b32 s27, s27, 0x3fff
    s_waitcnt vmcnt(5)
    buffer_load_dwordx4 v[116:119], v3, s[8:11], s27 offen nt
    s_add_u32 s27, s27, 1024
    s_and_b32 s27, s27, 0x3fff
    s_waitcnt vmcnt(5)
    buffer_load_dwordx4 v[120:123], v3, s[8:11], s27 offen nt
    s_add_u32 s27, s27, 1024
    s_and_b32 s27, s27, 0x3fff
    s_waitcnt vmcnt(5)
    buffer_load_dwordx4 v[124:127], v3, s[8:11], s27 offen nt
    s_branch k4_5
k3_4:
    v_mov_b32 v1, 0
spin_9:
    ds_read_b32 v2, v1 offset:80
    s_waitcnt lgkmcnt(0)
    v_readfirstlane_b32 s24, v2
    s_nop 0
    s_cmp_ge_u32 s24, 4
    s_cbranch_scc1 spun_10
    s_cmp_eq_u32 s80, 0
    s_cbranch_scc1 spun_10
    s_sub_u32 s80, s80, 1
    s_sleep 2
    s_branch spin_9
spun_10:
    buffer_load_dwordx4 v[64:67], v3, s[8:11], s27 offen nt
    s_add_u32 s27, s27, 1024
    s_and_b32 s27, s27, 0x3fff
    buffer_load_dwordx4 v[68:71], v3, s[8:11], s27 offen nt
    s_add_u32 s27, s27, 1024
    s_and_b32 s27, s27, 0x3fff
    buffer_load_dwordx4 v[72:75], v3, s[8:11], s27 offen nt
    s_add_u32 s27, s27, 1024
    s_and_b32 s27, s27, 0x3fff
    buffer_load_dwordx4 v[76:79], v3, s[8:11], s27 offen nt
    s_add_u32 s27, s27, 1024
    s_and_b32 s27, s27, 0x3fff
    buffer_load_dwordx4 v[80:83], v3, s[8:11], s27 offen nt
    s_add_u32 s27, s27, 1024
    s_and_b32 s27, s27, 0x3fff
    buffer_load_dwordx4 v[84:87], v3, s[8:11], s27 offen nt
    s_add_u32 s27, s27, 1024
    s_and_b32 s27, s27, 0x3fff
    buffer_load_dwordx4 v[88:91], v3, s[8:11], s27 offen nt
    s_add_u32 s27, s27, 1024
    s_and_b32 s27, s27, 0x3fff
    buffer_load_dwordx4 v[92:95], v3, s[8:11], s27 offen nt
    s_add_u32 s27, s27, 1024
    s_and_b32 s27, s27, 0x3fff
    s_waitcnt vmcnt(7)
    buffer_load_dwordx4 v[96:99], v3, s[8:11], s27 offen nt
    s_add_u32 s27, s27, 1024
    s_and_b32 s27, s27, 0x3fff
    s_waitcnt vmcnt(7)
    buffer_load_dwordx4 v[100:103], v3, s[8:11], s27 offen nt
    s_add_u32 s27, s27, 1024
    s_and_b32 s27, s27, 0x3fff
    s_waitcnt vmcnt(7)
    buffer_load_dwordx4 v[104:107], v3, s[8:11], s27 offen nt
    s_add_u32 s27, s27, 1024
    s_and_b32 s27, s27, 0x3fff
    s_waitcnt vmcnt(7)
    buffer_load_dwordx4 v[108:111], v3, s[8:11], s27 offen nt
    s_add_u32 s27, s27, 1024
    s_and_b32 s27, s27, 0x3fff
    s_waitcnt vmcnt(7)
    buffer_load_dwordx4 v[112:115], v3, s[8:11], s27 offen nt
    s_add_u32 s27, s27, 1024
    s_and_b32 s27, s27, 0x3fff
    s_waitcnt vmcnt(7)
    buffer_load_dwordx4 v[116:119], v3, s[8:11], s27 offen nt
    s_add_u32 s27, s27, 1024
    s_and_b32 s27, s27, 0x3fff
    s_waitcnt vmcnt(7)
    buffer_load_dwordx4 v[120:123], v3, s[8:11], s27 offen nt
    s_add_u32 s27, s27, 1024
    s_and_b32 s27, s27, 0x3fff
    s_waitcnt vmcnt(7)
    buffer_load_dwordx4 v[124:127], v3, s[8:11], s27 offen nt
k4_5:
    v_mov_b32 v1, 0
    v_mov_b32 v2, 1
    s_mov_b64 s[86:87], exec
    s_mov_b64 exec, 1
    ds_add_u32 v1, v2 offset:88
    s_mov_b64 exec, s[86:87]
    s_branch L_K2
L_VROLE:
    v_lshlrev_b32 v3, 4, v0
    s_cmp_eq_u32 s21, 0
    s_cbranch_scc0 noz_11
    v_mov_b32 v1, 0
    v_lshlrev_b32 v2, 2, v0
    ds_write_b32 v2, v1
    s_waitcnt lgkmcnt(0)
noz_11:
    s_barrier
    s_branch L_V2
L_CHAIN2:
    s_nop 4
    s_mov_b32 s70, 0x05040100
    s_mov_b32 s71, 0x07060302
    s_mov_b32 s72, 0x7060500
    s_mov_b32 s73, 0x7060501
    s_mov_b32 s74, 0x7060502
    s_mov_b32 s75, 0x7060503
    s_mov_b32 s88, 0xffff0000
    s_mov_b32 s89, 0x3fb8aa3b
    s_mov_b32 s80, 0x20000
    s_mov_b32 s4, s58
    s_mov_b32 s5, s59
    s_and_b32 s5, s5, 0xffff
    s_mov_b32 s6, 268435456
    s_mov_b32 s7, 0x00020000
    s_waitcnt lgkmcnt(0)
    s_add_u32 s18, s60, 0x9E3779B9
    s_mov_b32 s76, s18
    s_lshr_b32 s77, s18, 8
    s_lshr_b32 s78, s18, 16
    s_lshr_b32 s79, s18, 24
    v_mov_b32 v3, s18
    s_cmp_eq_u32 s63, 0
    s_cbranch_scc1 noM_12
    s_waitcnt vmcnt(8)
    v_lshlrev_b32 v8, 16, v4
    v_and_b32 v9, s88, v4
    v_lshlrev_b32 v10, 16, v5
    v_and_b32 v11, s88, v5
    v_lshlrev_b32 v12, 16, v6
    v_and_b32 v13, s88, v6
    v_lshlrev_b32 v14, 16, v7
    v_and_b32 v15, s88, v7
    v_mul_f32 v16, s89, v8
    v_mul_f32 v17, s89, v9
    v_mul_f32 v18, s89, v10
    v_mul_f32 v19, s89, v11
    v_mul_f32 v20, s89, v12
    v_mul_f32 v21, s89, v13
    v_mul_f32 v22, s89, v14
    v_mul_f32 v23, s89, v15
    v_exp_f32 v16, -v16
    v_exp_f32 v17, -v17
    v_exp_f32 v18, -v18
    v_exp_f32 v19, -v19
    v_exp_f32 v20, -v20
    v_exp_f32 v21, -v21
    v_exp_f32 v22, -v22
    v_exp_f32 v23, -v23
    v_add_f32 v16, 1.0, v16
    v_add_f32 v17, 1.0, v17
    v_add_f32 v18, 1.0, v18
    v_add_f32 v19, 1.0, v19
    v_add_f32 v20, 1.0, v20
    v_add_f32 v21, 1.0, v21
    v_add_f32 v22, 1.0, v22
    v_add_f32 v23, 1.0, v23
    v_rcp_f32 v24, v16
    s_nop 0
    v_mul_f32 v25, v8, v24
    v_fma_f32 v26, -v25, v16, v8
    v_fma_f32 v8, v26, v24, v25
    v_rcp_f32 v24, v17
    s_nop 0
    v_mul_f32 v25, v9, v24
    v_fma_f32 v26, -v25, v17, v9
    v_fma_f32 v9, v26, v24, v25
    v_rcp_f32 v24, v18
    s_nop 0
    v_mul_f32 v25, v10, v24
    v_fma_f32 v26, -v25, v18, v10
    v_fma_f32 v10, v26, v24, v25
    v_rcp_f32 v24, v19
    s_nop 0
    v_mul_f32 v25, v11, v24
    v_fma_f32 v26, -v25, v19, v11
    v_fma_f32 v11, v26, v24, v25
    v_rcp_f32 v24, v20
    s_nop 0
    v_mul_f32 v25, v12, v24
    v_fma_f32 v26, -v25, v20, v12
    v_fma_f32 v12, v26, v24, v25
    v_rcp_f32 v24, v21
    s_nop 0
    v_mul_f32 v25, v13, v24
    v_fma_f32 v26, -v25, v21, v13
    v_fma_f32 v13, v26, v24, v25
    v_rcp_f32 v24, v22
    s_nop 0
    v_mul_f32 v25, v14, v24
    v_fma_f32 v26, -v25, v22, v14
    v_fma_f32 v14, v26, v24, v25
    v_rcp_f32 v24, v23
    s_nop 0
    v_mul_f32 v25, v15, v24
    v_fma_f32 v26, -v25, v23, v15
    v_fma_f32 v15, v26, v24, v25
    v_cvt_pk_bf16_f32 v4, v8, v9
    v_cvt_pk_bf16_f32 v5, v10, v11
    v_cvt_pk_bf16_f32 v6, v12, v13
    v_cvt_pk_bf16_f32 v7, v14, v15
    v_lshrrev_b32 v1, 4, v0
    v_lshlrev_b32 v1, 3, v1
    v_and_b32 v2, 7, v0
    v_add_u32 v1, v1, v2
    v_lshlrev_b32 v1, 5, v1
    s_lshl_b32 s24, s21, 10
    v_add_u32 v2, s24, v1
    s_waitcnt vmcnt(0)
    v_mov_b32 v8, 0
    v_mov_b32 v9, 1
    s_mov_b64 s[86:87], exec
    s_mov_b64 exec, 1
    ds_add_u32 v8, v9 offset:76
    s_mov_b64 exec, s[86:87]
    v_perm_b32 v128, v36, v32, s70
    v_perm_b32 v129, v44, v40, s70
    v_perm_b32 v130, v52, v48, s70
    v_perm_b32 v131, v60, v56, s70
    v_perm_b32 v132, v36, v32, s71
    v_perm_b32 v133, v44, v40, s71
    v_perm_b32 v134, v52, v48, s71
    v_perm_b32 v135, v60, v56, s71
    v_perm_b32 v136, v37, v33, s70
    v_perm_b32 v137, v45, v41, s70
    v_perm_b32 v138, v53, v49, s70
    v_perm_b32 v139, v61, v57, s70
    v_perm_b32 v140, v37, v33, s71
    v_perm_b32 v141, v45, v41, s71
    v_perm_b32 v142, v53, v49, s71
    v_perm_b32 v143, v61, v57, s71
    v_mfma_f32_16x16x32_bf16 v[64:67], v[4:7], v[128:131], 0
    v_mfma_f32_16x16x32_bf16 v[68:71], v[4:7], v[132:135], 0
    v_perm_b32 v144, v38, v34, s70
    v_perm_b32 v145, v46, v42, s70
    v_perm_b32 v146, v54, v50, s70
    v_perm_b32 v147, v62, v58, s70
    v_perm_b32 v148, v38, v34, s71
    v_perm_b32 v149, v46, v42, s71
    v_perm_b32 v150, v54, v50, s71
    v_perm_b32 v151, v62, v58, s71
    v_mfma_f32_16x16x32_bf16 v[72:75], v[4:7], v[136:139], 0
    v_mfma_f32_16x16x32_bf16 v[76:79], v[4:7], v[140:143], 0
    v_perm_b32 v152, v39, v35, s70
    v_perm_b32 v153, v47, v43, s70
    v_perm_b32 v154, v55, v51, s70
    v_perm_b32 v155, v63, v59, s70
    v_perm_b32 v156, v39, v35, s71
    v_perm_b32 v157, v47, v43, s71
    v_perm_b32 v158, v55, v51, s71
    v_perm_b32 v159, v63, v59, s71
    v_mfma_f32_16x16x32_bf16 v[80:83], v[4:7], v[144:147], 0
    v_mfma_f32_16x16x32_bf16 v[84:87], v[4:7], v[148:151], 0
    v_mfma_f32_16x16x32_bf16 v[88:91], v[4:7], v[152:155], 0
    v_mfma_f32_16x16x32_bf16 v[92:95], v[4:7], v[156:159], 0
    v_add_f32_dpp v8, v65, v64 row_ror:8 row_mask:0xf bank_mask:0xf
    v_add_f32_dpp v9, v67, v66 row_ror:8 row_mask:0xf bank_mask:0xf
    v_add_f32_dpp v10, v69, v68 row_ror:8 row_mask:0xf bank_mask:0xf
    v_add_f32_dpp v11, v71, v70 row_ror:8 row_mask:0xf bank_mask:0xf
    v_add_f32_dpp v12, v73, v72 row_ror:8 row_mask:0xf bank_mask:0xf
    v_add_f32_dpp v13, v75, v74 row_ror:8 row_mask:0xf bank_mask:0xf
    v_add_f32_dpp v14, v77, v76 row_ror:8 row_mask:0xf bank_mask:0xf
    v_add_f32_dpp v15, v79, v78 row_ror:8 row_mask:0xf bank_mask:0xf
    v_add_f32_dpp v16, v81, v80 row_ror:8 row_mask:0xf bank_mask:0xf
    v_add_f32_dpp v17, v83, v82 row_ror:8 row_mask:0xf bank_mask:0xf
    v_add_f32_dpp v18, v85, v84 row_ror:8 row_mask:0xf bank_mask:0xf
    v_add_f32_dpp v19, v87, v86 row_ror:8 row_mask:0xf bank_mask:0xf
    v_add_f32_dpp v20, v89, v88 row_ror:8 row_mask:0xf bank_mask:0xf
    v_add_f32_dpp v21, v91, v90 row_ror:8 row_mask:0xf bank_mask:0xf
    v_add_f32_dpp v22, v93, v92 row_ror:8 row_mask:0xf bank_mask:0xf
    v_add_f32_dpp v23, v95, v94 row_ror:8 row_mask:0xf bank_mask:0xf
    v_permlane32_swap_b32 v8, v9
    v_permlane32_swap_b32 v10, v11
    v_permlane32_swap_b32 v12, v13
    v_permlane32_swap_b32 v14, v15
    v_permlane32_swap_b32 v16, v17
    v_permlane32_swap_b32 v18, v19
    v_permlane32_swap_b32 v20, v21
    v_permlane32_swap_b32 v22, v23
    v_mov_b32 v24, v8
    v_mov_b32 v25, v10
    v_mov_b32 v26, v12
    v_mov_b32 v27, v14
    v_mov_b32 v28, v16
    v_mov_b32 v29, v18
    v_mov_b32 v30, v20
    v_mov_b32 v31, v22
    s_mov_b32 exec_lo, 0xff00ff
    s_mov_b32 exec_hi, 0xff00ff
    ds_write_b128 v2, v[24:27] offset:3328
    ds_write_b128 v2, v[28:31] offset:3344
    s_mov_b64 exec, -1
    v_mov_b32 v8, 0
    v_mov_b32 v9, 1
    s_mov_b64 s[86:87], exec
    s_mov_b64 exec, 1
    ds_add_u32 v8, v9 offset:36
    s_mov_b64 exec, s[86:87]
noM_12:
    s_cmp_lt_u32 s85, 8
    s_cbranch_scc0 nx_13
    s_mov_b32 s12, s32
    s_mov_b32 s13, s33
    s_and_b32 s13, s13, 0xffff
    s_mov_b32 s14, 4096
    s_mov_b32 s15, 0x00020000
    v_lshrrev_b32 v8, 4, v0
    v_lshlrev_b32 v8, 10, v8
    v_and_b32 v9, 15, v0
    v_lshlrev_b32 v9, 6, v9
    v_add_u32 v8, v8, v9
    buffer_load_dwordx4 v[128:131], v8, s[12:15], 0 offen offset:0
    buffer_load_dwordx4 v[132:135], v8, s[12:15], 0 offen offset:16
    buffer_load_dwordx4 v[136:139], v8, s[12:15], 0 offen offset:32
    buffer_load_dwordx4 v[140:143], v8, s[12:15], 0 offen offset:48
    v_bfe_u32 v10, v0, 1, 2
    v_lshrrev_b32 v11, 4, v0
    v_lshlrev_b32 v11, 1, v11
    v_and_b32 v1, 1, v0
    v_add_u32 v11, v11, v1
    v_and_b32 v1, 8, v0
    v_add_u32 v11, v11, v1
    v_lshlrev_b32 v8, 10, v10
    v_lshlrev_b32 v9, 4, v11
    v_add_u32 v8, v8, v9
    s_lshl_b32 s24, s21, 8
    buffer_load_dwordx4 v[144:147], v8, s[12:15], s24 offen
nx_13:
    s_cmp_eq_u32 s63, 0
    s_cbranch_scc1 noM_14
    s_cmp_eq_u32 s21, 0
    s_cbranch_scc0 noM_14
    v_bfe_u32 v8, v0, 4, 1
    v_lshlrev_b32 v8, 1, v8
    v_lshrrev_b32 v9, 5, v0
    v_add_u32 v8, v8, v9
    v_and_b32 v9, 7, v0
    s_and_b32 s24, s61, 1
    s_lshl_b32 s24, s24, 3
    v_add_u32 v9, s24, v9
    v_bfe_u32 v11, v9, 1, 2
    v_lshlrev_b32 v10, 4, v11
    v_and_b32 v11, 8, v9
    v_add_u32 v10, v10, v11
    v_and_b32 v11, 1, v9
    v_add_u32 v10, v10, v11
    v_lshl_add_u32 v10, v8, 1, v10
    v_lshlrev_b32 v8, 4, v10
    s_mul_i32 s24, s62, 6
    s_lshr_b32 s25, s61, 3
    s_add_u32 s24, s24, s25
    s_lshl_b32 s24, s24, 2
    s_bfe_u32 s25, s61, 0x20001
    s_add_u32 s24, s24, s25
    s_mul_i32 s24, s24, 3072
    s_add_u32 s28, s24, 65536
    v_mov_b32 v19, v3
    v_mov_b32 v23, v3
    v_mov_b32 v26, v3
    v_mov_b32 v27, v3
    v_lshrrev_b32 v1, 4, v0
    v_lshlrev_b32 v1, 3, v1
    v_and_b32 v2, 7, v0
    v_add_u32 v1, v1, v2
    v_lshlrev_b32 v1, 5, v1
    v_mov_b32 v10, 0
spinw_15:
    ds_read_b32 v11, v10 offset:36
    ds_read_b128 v[32:35], v1 offset:3328
    ds_read_b128 v[36:39], v1 offset:3344
    ds_read_b128 v[40:43], v1 offset:4352
    ds_read_b128 v[44:47], v1 offset:4368
    ds_read_b128 v[48:51], v1 offset:5376
    ds_read_b128 v[52:55], v1 offset:5392
    ds_read_b128 v[56:59], v1 offset:6400
    ds_read_b128 v[60:63], v1 offset:6416
    s_waitcnt lgkmcnt(0)
    v_readfirstlane_b32 s24, v11
    s_nop 0
    s_cmp_ge_u32 s24, 4
    s_cbranch_scc1 spunw_16
    s_cmp_eq_u32 s80, 0
    s_cbranch_scc1 spunw_16
    s_sub_u32 s80, s80, 1
    s_branch spinw_15
spunw_16:
    v_pk_add_f32 v[32:33], v[32:33], v[40:41]
    v_pk_add_f32 v[34:35], v[34:35], v[42:43]
    v_pk_add_f32 v[36:37], v[36:37], v[44:45]
    v_pk_add_f32 v[38:39], v[38:39], v[46:47]
    v_pk_add_f32 v[48:49], v[48:49], v[56:57]
    v_pk_add_f32 v[50:51], v[50:51], v[58:59]
    v_pk_add_f32 v[52:53], v[52:53], v[60:61]
    v_pk_add_f32 v[54:55], v[54:55], v[62:63]
    v_add_f32 v16, v32, v48
    v_add_f32 v17, v33, v49
    v_add_f32 v18, v34, v50
    v_add_f32 v20, v35, v51
    v_add_f32 v21, v36, v52
    v_add_f32 v22, v37, v53
    v_add_f32 v24, v38, v54
    v_add_f32 v25, v39, v55
    s_mov_b32 exec_lo, 0xff00ff
    s_mov_b32 exec_hi, 0xff00ff
    buffer_store_dwordx4 v[16:19], v8, s[4:7], s28 offen offset:0 sc1
    buffer_store_dwordx4 v[20:23], v8, s[4:7], s28 offen offset:1024 sc1
    buffer_store_dwordx4 v[24:27], v8, s[4:7], s28 offen offset:2048 sc1
    s_mov_b64 exec, -1
noM_14:
    s_cmp_lt_u32 s85, 8
    s_cbranch_scc0 noQ_17
    v_bfe_u32 v10, v0, 1, 2
    v_lshrrev_b32 v11, 4, v0
    v_lshlrev_b32 v11, 1, v11
    v_and_b32 v1, 1, v0
    v_add_u32 v11, v11, v1
    v_and_b32 v1, 8, v0
    v_add_u32 v11, v11, v1
    v_lshrrev_b32 v160, 4, v0
    v_lshlrev_b32 v160, 3, v160
    v_and_b32 v161, 7, v0
    v_add_u32 v160, v160, v161
    v_lshlrev_b32 v160, 5, v160
    s_lshl_b32 s24, s21, 10
    v_add_u32 v161, s24, v160
    s_waitcnt vmcnt(13)
    v_perm_b32 v32, v68, v64, s70
    v_perm_b32 v36, v68, v64, s71
    v_perm_b32 v33, v76, v72, s70
    v_perm_b32 v37, v76, v72, s71
    v_perm_b32 v34, v84, v80, s70
    v_perm_b32 v38, v84, v80, s71
    v_perm_b32 v35, v92, v88, s70
    v_perm_b32 v39, v92, v88, s71
    v_perm_b32 v40, v69, v65, s70
    v_perm_b32 v44, v69, v65, s71
    v_perm_b32 v41, v77, v73, s70
    v_perm_b32 v45, v77, v73, s71
    v_perm_b32 v42, v85, v81, s70
    v_perm_b32 v46, v85, v81, s71
    v_perm_b32 v43, v93, v89, s70
    v_perm_b32 v47, v93, v89, s71
    v_perm_b32 v48, v70, v66, s70
    v_perm_b32 v52, v70, v66, s71
    v_perm_b32 v49, v78, v74, s70
    v_perm_b32 v53, v78, v74, s71
    v_perm_b32 v50, v86, v82, s70
    v_perm_b32 v54, v86, v82, s71
    v_perm_b32 v51, v94, v90, s70
    v_perm_b32 v55, v94, v90, s71
    v_perm_b32 v56, v71, v67, s70
    v_perm_b32 v60, v71, v67, s71
    v_perm_b32 v57, v79, v75, s70
    v_perm_b32 v61, v79, v75, s71
    v_perm_b32 v58, v87, v83, s70
    v_perm_b32 v62, v87, v83, s71
    v_perm_b32 v59, v95, v91, s70
    v_perm_b32 v63, v95, v91, s71
    s_waitcnt vmcnt(5)
    v_perm_b32 v64, v100, v96, s70
    v_perm_b32 v68, v100, v96, s71
    v_perm_b32 v65, v108, v104, s70
    v_perm_b32 v69, v108, v104, s71
    v_perm_b32 v66, v116, v112, s70
    v_perm_b32 v70, v116, v112, s71
    v_perm_b32 v67, v124, v120, s70
    v_perm_b32 v71, v124, v120, s71
    v_perm_b32 v72, v101, v97, s70
    v_perm_b32 v76, v101, v97, s71
    v_perm_b32 v73, v109, v105, s70
    v_perm_b32 v77, v109, v105, s71
    v_perm_b32 v74, v117, v113, s70
    v_perm_b32 v78, v117, v113, s71
    v_perm_b32 v75, v125, v121, s70
    v_perm_b32 v79, v125, v121, s71
    v_perm_b32 v80, v102, v98, s70
    v_perm_b32 v84, v102, v98, s71
    v_perm_b32 v81, v110, v106, s70
    v_perm_b32 v85, v110, v106, s71
    v_perm_b32 v82, v118, v114, s70
    v_perm_b32 v86, v118, v114, s71
    v_perm_b32 v83, v126, v122, s70
    v_perm_b32 v87, v126, v122, s71
    v_perm_b32 v88, v103, v99, s70
    v_perm_b32 v92, v103, v99, s71
    v_perm_b32 v89, v111, v107, s70
    v_perm_b32 v93, v111, v107, s71
    v_perm_b32 v90, v119, v115, s70
    v_perm_b32 v94, v119, v115, s71
    v_perm_b32 v91, v127, v123, s70
    v_perm_b32 v95, v127, v123, s71
    s_waitcnt vmcnt(0)
    v_lshlrev_b32 v96, 16, v128
    v_and_b32 v97, s88, v128
    v_lshlrev_b32 v98, 16, v129
    v_and_b32 v99, s88, v129
    v_lshlrev_b32 v100, 16, v130
    v_and_b32 v101, s88, v130
    v_lshlrev_b32 v102, 16, v131
    v_and_b32 v103, s88, v131
    v_lshlrev_b32 v104, 16, v132
    v_and_b32 v105, s88, v132
    v_lshlrev_b32 v106, 16, v133
    v_and_b32 v107, s88, v133
    v_lshlrev_b32 v108, 16, v134
    v_and_b32 v109, s88, v134
    v_lshlrev_b32 v110, 16, v135
    v_and_b32 v111, s88, v135
    v_lshlrev_b32 v112, 16, v136
    v_and_b32 v113, s88, v136
    v_lshlrev_b32 v114, 16, v137
    v_and_b32 v115, s88, v137
    v_lshlrev_b32 v116, 16, v138
    v_and_b32 v117, s88, v138
    v_lshlrev_b32 v118, 16, v139
    v_and_b32 v119, s88, v139
    v_lshlrev_b32 v120, 16, v140
    v_and_b32 v121, s88, v140
    v_lshlrev_b32 v122, 16, v141
    v_and_b32 v123, s88, v141
    v_lshlrev_b32 v124, 16, v142
    v_and_b32 v125, s88, v142
    v_lshlrev_b32 v126, 16, v143
    v_and_b32 v127, s88, v143
    v_pk_add_f32 v[148:149], v[96:97], v[98:99]
    v_pk_add_f32 v[148:149], v[148:149], v[100:101]
    v_pk_add_f32 v[148:149], v[148:149], v[102:103]
    v_pk_add_f32 v[148:149], v[148:149], v[104:105]
    v_pk_add_f32 v[148:149], v[148:149], v[106:107]
    v_pk_add_f32 v[148:149], v[148:149], v[108:109]
    v_pk_add_f32 v[148:149], v[148:149], v[110:111]
    v_pk_add_f32 v[148:149], v[148:149], v[112:113]
    v_pk_add_f32 v[148:149], v[148:149], v[114:115]
    v_pk_add_f32 v[148:149], v[148:149], v[116:117]
    v_pk_add_f32 v[148:149], v[148:149], v[118:119]
    v_pk_add_f32 v[148:149], v[148:149], v[120:121]
    v_pk_add_f32 v[148:149], v[148:149], v[122:123]
    v_pk_add_f32 v[148:149], v[148:149], v[124:125]
    v_pk_add_f32 v[148:149], v[148:149], v[126:127]
    v_add_f32 v148, v148, v149
    s_nop 1
    v_add_f32_dpp v148, v148, v148 row_ror:8 row_mask:0xf bank_mask:0xf
    s_nop 1
    v_add_f32_dpp v148, v148, v148 row_ror:4 row_mask:0xf bank_mask:0xf
    s_nop 1
    v_add_f32_dpp v148, v148, v148 row_ror:2 row_mask:0xf bank_mask:0xf
    s_nop 1
    v_add_f32_dpp v148, v148, v148 row_ror:1 row_mask:0xf bank_mask:0xf
    v_mul_f32 v150, 0x3b000000, v148
    v_mov_b32 v151, v150
    v_mov_b32 v148, 0
    v_mov_b32 v149, 0
    v_pk_add_f32 v[152:153], v[96:97], v[150:151] neg_lo:[0,1] neg_hi:[0,1]
    v_pk_fma_f32 v[148:149], v[152:153], v[152:153], v[148:149]
    v_pk_add_f32 v[152:153], v[98:99], v[150:151] neg_lo:[0,1] neg_hi:[0,1]
    v_pk_fma_f32 v[148:149], v[152:153], v[152:153], v[148:149]
    v_pk_add_f32 v[152:153], v[100:101], v[150:151] neg_lo:[0,1] neg_hi:[0,1]
    v_pk_fma_f32 v[148:149], v[152:153], v[152:153], v[148:149]
    v_pk_add_f32 v[152:153], v[102:103], v[150:151] neg_lo:[0,1] neg_hi:[0,1]
    v_pk_fma_f32 v[148:149], v[152:153], v[152:153], v[148:149]
    v_pk_add_f32 v[152:153], v[104:105], v[150:151] neg_lo:[0,1] neg_hi:[0,1]
    v_pk_fma_f32 v[148:149], v[152:153], v[152:153], v[148:149]
    v_pk_add_f32 v[152:153], v[106:107], v[150:151] neg_lo:[0,1] neg_hi:[0,1]
    v_pk_fma_f32 v[148:149], v[152:153], v[152:153], v[148:149]
    v_pk_add_f32 v[152:153], v[108:109], v[150:151] neg_lo:[0,1] neg_hi:[0,1]
    v_pk_fma_f32 v[148:149], v[152:153], v[152:153], v[148:149]
    v_pk_add_f32 v[152:153], v[110:111], v[150:151] neg_lo:[0,1] neg_hi:[0,1]
    v_pk_fma_f32 v[148:149], v[152:153], v[152:153], v[148:149]
    v_pk_add_f32 v[152:153], v[112:113], v[150:151] neg_lo:[0,1] neg_hi:[0,1]
    v_pk_fma_f32 v[148:149], v[152:153], v[152:153], v[148:149]
    v_pk_add_f32 v[152:153], v[114:115], v[150:151] neg_lo:[0,1] neg_hi:[0,1]
    v_pk_fma_f32 v[148:149], v[152:153], v[152:153], v[148:149]
    v_pk_add_f32 v[152:153], v[116:117], v[150:151] neg_lo:[0,1] neg_hi:[0,1]
    v_pk_fma_f32 v[148:149], v[152:153], v[152:153], v[148:149]
    v_pk_add_f32 v[152:153], v[118:119], v[150:151] neg_lo:[0,1] neg_hi:[0,1]
    v_pk_fma_f32 v[148:149], v[152:153], v[152:153], v[148:149]
    v_pk_add_f32 v[152:153], v[120:121], v[150:151] neg_lo:[0,1] neg_hi:[0,1]
    v_pk_fma_f32 v[148:149], v[152:153], v[152:153], v[148:149]
    v_pk_add_f32 v[152:153], v[122:123], v[150:151] neg_lo:[0,1] neg_hi:[0,1]
    v_pk_fma_f32 v[148:149], v[152:153], v[152:153], v[148:149]
    v_pk_add_f32 v[152:153], v[124:125], v[150:151] neg_lo:[0,1] neg_hi:[0,1]
    v_pk_fma_f32 v[148:149], v[152:153], v[152:153], v[148:149]
    v_pk_add_f32 v[152:153], v[126:127], v[150:151] neg_lo:[0,1] neg_hi:[0,1]
    v_pk_fma_f32 v[148:149], v[152:153], v[152:153], v[148:149]
    v_add_f32 v148, v148, v149
    s_nop 1
    v_add_f32_dpp v148, v148, v148 row_ror:8 row_mask:0xf bank_mask:0xf
    s_nop 1
    v_add_f32_dpp v148, v148, v148 row_ror:4 row_mask:0xf bank_mask:0xf
    s_nop 1
    v_add_f32_dpp v148, v148, v148 row_ror:2 row_mask:0xf bank_mask:0xf
    s_nop 1
    v_add_f32_dpp v148, v148, v148 row_ror:1 row_mask:0xf bank_mask:0xf
    v_mul_f32 v148, 0x3b000000, v148
    v_cvt_pk_bf16_f32 v152, v148, v150
    v_lshlrev_b32 v148, 16, v152
    v_and_b32 v150, s88, v152
    v_mov_b32 v12, v150
    v_add_f32 v148, 0x3727c5ac, v148
    v_cvt_pk_bf16_f32 v152, v148, v149
    v_lshlrev_b32 v148, 16, v152
    v_and_b32 v149, s88, v152
    v_sqrt_f32 v148, v148
    s_nop 0
    v_cvt_pk_bf16_f32 v152, v148, v149
    v_lshlrev_b32 v148, 16, v152
    v_and_b32 v149, s88, v152
    v_mov_b32 v13, v148
    v_lshlrev_b32 v14, 6, v10
    ds_bpermute_b32 v12, v14, v12
    ds_bpermute_b32 v13, v14, v13
    s_waitcnt lgkmcnt(0)
    v_lshlrev_b32 v16, 16, v144
    v_and_b32 v17, s88, v144
    v_lshlrev_b32 v18, 16, v145
    v_and_b32 v19, s88, v145
    v_lshlrev_b32 v20, 16, v146
    v_and_b32 v21, s88, v146
    v_lshlrev_b32 v22, 16, v147
    v_and_b32 v23, s88, v147
    v_rcp_f32 v100, v13
    v_sub_f32 v16, v16, v12
    v_sub_f32 v17, v17, v12
    v_sub_f32 v18, v18, v12
    v_sub_f32 v19, v19, v12
    v_sub_f32 v20, v20, v12
    v_sub_f32 v21, v21, v12
    v_sub_f32 v22, v22, v12
    v_sub_f32 v23, v23, v12
    v_cvt_pk_bf16_f32 v101, v16, v17
    v_lshlrev_b32 v16, 16, v101
    v_and_b32 v17, s88, v101
    v_cvt_pk_bf16_f32 v102, v18, v19
    v_lshlrev_b32 v18, 16, v102
    v_and_b32 v19, s88, v102
    v_cvt_pk_bf16_f32 v101, v20, v21
    v_lshlrev_b32 v20, 16, v101
    v_and_b32 v21, s88, v101
    v_cvt_pk_bf16_f32 v102, v22, v23
    v_lshlrev_b32 v22, 16, v102
    v_and_b32 v23, s88, v102
    v_mul_f32 v103, v16, v100
    v_fma_f32 v16, -v103, v13, v16
    v_fma_f32 v16, v16, v100, v103
    v_mul_f32 v103, v17, v100
    v_fma_f32 v17, -v103, v13, v17
    v_fma_f32 v17, v17, v100, v103
    v_mul_f32 v103, v18, v100
    v_fma_f32 v18, -v103, v13, v18
    v_fma_f32 v18, v18, v100, v103
    v_mul_f32 v103, v19, v100
    v_fma_f32 v19, -v103, v13, v19
    v_fma_f32 v19, v19, v100, v103
    v_mul_f32 v103, v20, v100
    v_fma_f32 v20, -v103, v13, v20
    v_fma_f32 v20, v20, v100, v103
    v_mul_f32 v103, v21, v100
    v_fma_f32 v21, -v103, v13, v21
    v_fma_f32 v21, v21, v100, v103
    v_mul_f32 v103, v22, v100
    v_fma_f32 v22, -v103, v13, v22
    v_fma_f32 v22, v22, v100, v103
    v_mul_f32 v103, v23, v100
    v_fma_f32 v23, -v103, v13, v23
    v_fma_f32 v23, v23, v100, v103
    v_cvt_pk_bf16_f32 v101, v16, v17
    v_lshlrev_b32 v16, 16, v101
    v_and_b32 v17, s88, v101
    v_cvt_pk_bf16_f32 v102, v18, v19
    v_lshlrev_b32 v18, 16, v102
    v_and_b32 v19, s88, v102
    v_cvt_pk_bf16_f32 v101, v20, v21
    v_lshlrev_b32 v20, 16, v101
    v_and_b32 v21, s88, v101
    v_cvt_pk_bf16_f32 v102, v22, v23
    v_lshlrev_b32 v22, 16, v102
    v_and_b32 v23, s88, v102
    v_lshlrev_b32 v8, 4, v0
    s_mul_i32 s28, s21, 3072
    s_add_u32 s28, s28, 65536
    s_mul_i32 s29, s21, 3072
    s_add_u32 s29, s29, 139264
    s_mul_i32 s30, s21, 3072
    s_add_u32 s30, s30, 77824
    s_mul_i32 s31, s21, 3072
    s_add_u32 s31, s31, 151552
    s_mov_b32 s64, 0xff00ff00
    s_mov_b32 s65, 0xff00ff00
poll_18:
    buffer_load_dwordx4 v[96:99], v8, s[4:7], s28 offen offset:0 sc1
    buffer_load_dwordx4 v[100:103], v8, s[4:7], s28 offen offset:1024 sc1
    buffer_load_dwordx4 v[104:107], v8, s[4:7], s28 offen offset:2048 sc1
    buffer_load_dwordx4 v[108:111], v8, s[4:7], s29 offen offset:0 sc1
    buffer_load_dwordx4 v[112:115], v8, s[4:7], s29 offen offset:1024 sc1
    buffer_load_dwordx4 v[116:119], v8, s[4:7], s29 offen offset:2048 sc1
    buffer_load_dwordx4 v[120:123], v8, s[4:7], s30 offen offset:0 sc1
    buffer_load_dwordx4 v[124:127], v8, s[4:7], s30 offen offset:1024 sc1
    buffer_load_dwordx4 v[128:131], v8, s[4:7], s30 offen offset:2048 sc1
    buffer_load_dwordx4 v[132:135], v8, s[4:7], s31 offen offset:0 sc1
    buffer_load_dwordx4 v[136:139], v8, s[4:7], s31 offen offset:1024 sc1
    buffer_load_dwordx4 v[140:143], v8, s[4:7], s31 offen offset:2048 sc1
    v_mov_b32 v9, 0
    s_waitcnt vmcnt(0)
    v_bitop3_b32 v9, v9, v99, s18 bitop3:0xf6
    v_bitop3_b32 v9, v9, v103, s18 bitop3:0xf6
    v_bitop3_b32 v9, v9, v107, s18 bitop3:0xf6
    v_bitop3_b32 v9, v9, v111, s18 bitop3:0xf6
    v_bitop3_b32 v9, v9, v115, s18 bitop3:0xf6
    v_bitop3_b32 v9, v9, v119, s18 bitop3:0xf6
    v_bitop3_b32 v9, v9, v123, s18 bitop3:0xf6
    v_bitop3_b32 v9, v9, v127, s18 bitop3:0xf6
    v_bitop3_b32 v9, v9, v131, s18 bitop3:0xf6
    v_bitop3_b32 v9, v9, v135, s18 bitop3:0xf6
    v_bitop3_b32 v9, v9, v139, s18 bitop3:0xf6
    v_bitop3_b32 v9, v9, v143, s18 bitop3:0xf6
    v_cmp_ne_u32 s[82:83], 0, v9
    s_nop 0
    s_cmp_eq_u64 s[82:83], 0
    s_cbranch_scc1 polled_19
    s_cmp_eq_u32 s80, 0
    s_cbranch_scc1 polled_19
    s_sub_u32 s80, s80, 1
    s_sleep 2
    s_branch poll_18
polled_19:
    v_mov_b32 v14, 0
    v_mov_b32 v15, 1
    s_mov_b64 s[86:87], exec
    s_mov_b64 exec, 1
    ds_add_u32 v14, v15 offset:80
    s_mov_b64 exec, s[86:87]
    v_pk_add_f32 v[24:25], v[96:97], v[108:109]
    v_add_f32 v26, v98, v110
    v_add_f32 v27, v100, v112
    v_add_f32 v28, v101, v113
    v_add_f32 v29, v102, v114
    v_pk_add_f32 v[30:31], v[104:105], v[116:117]
    v_pk_add_f32 v[4:5], v[120:121], v[132:133]
    v_add_f32 v6, v122, v134
    v_add_f32 v7, v124, v136
    v_add_f32 v8, v125, v137
    v_add_f32 v9, v126, v138
    v_pk_add_f32 v[10:11], v[128:129], v[140:141]
    v_cvt_pk_bf16_f32 v14, v24, v25
    v_lshlrev_b32 v24, 16, v14
    v_and_b32 v25, s88, v14
    v_cvt_pk_bf16_f32 v15, v26, v27
    v_lshlrev_b32 v26, 16, v15
    v_and_b32 v27, s88, v15
    v_cvt_pk_bf16_f32 v14, v28, v29
    v_lshlrev_b32 v28, 16, v14
    v_and_b32 v29, s88, v14
    v_cvt_pk_bf16_f32 v15, v30, v31
    v_lshlrev_b32 v30, 16, v15
    v_and_b32 v31, s88, v15
    v_cvt_pk_bf16_f32 v14, v4, v5
    v_lshlrev_b32 v4, 16, v14
    v_and_b32 v5, s88, v14
    v_cvt_pk_bf16_f32 v15, v6, v7
    v_lshlrev_b32 v6, 16, v15
    v_and_b32 v7, s88, v15
    v_cvt_pk_bf16_f32 v14, v8, v9
    v_lshlrev_b32 v8, 16, v14
    v_and_b32 v9, s88, v14
    v_cvt_pk_bf16_f32 v15, v10, v11
    v_lshlrev_b32 v10, 16, v15
    v_and_b32 v11, s88, v15
    v_add_f32 v4, 1.0, v4
    v_add_f32 v5, 1.0, v5
    v_add_f32 v6, 1.0, v6
    v_add_f32 v7, 1.0, v7
    v_add_f32 v8, 1.0, v8
    v_add_f32 v9, 1.0, v9
    v_add_f32 v10, 1.0, v10
    v_add_f32 v11, 1.0, v11
    v_cvt_pk_bf16_f32 v14, v4, v5
    v_lshlrev_b32 v4, 16, v14
    v_and_b32 v5, s88, v14
    v_cvt_pk_bf16_f32 v15, v6, v7
    v_lshlrev_b32 v6, 16, v15
    v_and_b32 v7, s88, v15
    v_cvt_pk_bf16_f32 v14, v8, v9
    v_lshlrev_b32 v8, 16, v14
    v_and_b32 v9, s88, v14
    v_cvt_pk_bf16_f32 v15, v10, v11
    v_lshlrev_b32 v10, 16, v15
    v_and_b32 v11, s88, v15
    v_pk_mul_f32 v[16:17], v[16:17], v[4:5]
    v_pk_mul_f32 v[18:19], v[18:19], v[6:7]
    v_pk_mul_f32 v[20:21], v[20:21], v[8:9]
    v_pk_mul_f32 v[22:23], v[22:23], v[10:11]
    v_cvt_pk_bf16_f32 v14, v16, v17
    v_lshlrev_b32 v16, 16, v14
    v_and_b32 v17, s88, v14
    v_cvt_pk_bf16_f32 v15, v18, v19
    v_lshlrev_b32 v18, 16, v15
    v_and_b32 v19, s88, v15
    v_cvt_pk_bf16_f32 v14, v20, v21
    v_lshlrev_b32 v20, 16, v14
    v_and_b32 v21, s88, v14
    v_cvt_pk_bf16_f32 v15, v22, v23
    v_lshlrev_b32 v22, 16, v15
    v_and_b32 v23, s88, v15
    v_pk_add_f32 v[16:17], v[16:17], v[24:25]
    v_pk_add_f32 v[18:19], v[18:19], v[26:27]
    v_pk_add_f32 v[20:21], v[20:21], v[28:29]
    v_pk_add_f32 v[22:23], v[22:23], v[30:31]
    v_cvt_pk_bf16_f32 v96, v16, v17
    v_cvt_pk_bf16_f32 v97, v18, v19
    v_cvt_pk_bf16_f32 v98, v20, v21
    v_cvt_pk_bf16_f32 v99, v22, v23
    v_cndmask_b32 v4, v96, 0, s[64:65]
    v_cndmask_b32 v16, 0, v96, s[64:65]
    v_cndmask_b32 v5, v97, 0, s[64:65]
    v_cndmask_b32 v17, 0, v97, s[64:65]
    v_cndmask_b32 v6, v98, 0, s[64:65]
    v_cndmask_b32 v18, 0, v98, s[64:65]
    v_cndmask_b32 v7, v99, 0, s[64:65]
    v_cndmask_b32 v19, 0, v99, s[64:65]
    s_nop 0
    v_mfma_f32_16x16x32_bf16 v[96:99], v[4:7], v[32:35], 0
    v_mfma_f32_16x16x32_bf16 v[100:103], v[4:7], v[36:39], 0
    v_mfma_f32_16x16x32_bf16 v[104:107], v[4:7], v[40:43], 0
    v_mfma_f32_16x16x32_bf16 v[108:111], v[4:7], v[44:47], 0
    v_mfma_f32_16x16x32_bf16 v[112:115], v[4:7], v[48:51], 0
    v_mfma_f32_16x16x32_bf16 v[116:119], v[4:7], v[52:55], 0
    v_mfma_f32_16x16x32_bf16 v[120:123], v[4:7], v[56:59], 0
    v_mfma_f32_16x16x32_bf16 v[124:127], v[4:7], v[60:63], 0
    v_mfma_f32_16x16x32_bf16 v[96:99], v[16:19], v[64:67], v[96:99]
    v_mfma_f32_16x16x32_bf16 v[100:103], v[16:19], v[68:71], v[100:103]
    v_mfma_f32_16x16x32_bf16 v[104:107], v[16:19], v[72:75], v[104:107]
    v_mfma_f32_16x16x32_bf16 v[108:111], v[16:19], v[76:79], v[108:111]
    v_mfma_f32_16x16x32_bf16 v[112:115], v[16:19], v[80:83], v[112:115]
    v_mfma_f32_16x16x32_bf16 v[116:119], v[16:19], v[84:87], v[116:119]
    v_mfma_f32_16x16x32_bf16 v[120:123], v[16:19], v[88:91], v[120:123]
    v_mfma_f32_16x16x32_bf16 v[124:127], v[16:19], v[92:95], v[124:127]
    s_nop 0
    v_add_f32_dpp v128, v97, v96 row_ror:8 row_mask:0xf bank_mask:0xf
    v_add_f32_dpp v129, v99, v98 row_ror:8 row_mask:0xf bank_mask:0xf
    v_add_f32_dpp v130, v101, v100 row_ror:8 row_mask:0xf bank_mask:0xf
    v_add_f32_dpp v131, v103, v102 row_ror:8 row_mask:0xf bank_mask:0xf
    v_add_f32_dpp v132, v105, v104 row_ror:8 row_mask:0xf bank_mask:0xf
    v_add_f32_dpp v133, v107, v106 row_ror:8 row_mask:0xf bank_mask:0xf
    v_add_f32_dpp v134, v109, v108 row_ror:8 row_mask:0xf bank_mask:0xf
    v_add_f32_dpp v135, v111, v110 row_ror:8 row_mask:0xf bank_mask:0xf
    v_add_f32_dpp v136, v113, v112 row_ror:8 row_mask:0xf bank_mask:0xf
    v_add_f32_dpp v137, v115, v114 row_ror:8 row_mask:0xf bank_mask:0xf
    v_add_f32_dpp v138, v117, v116 row_ror:8 row_mask:0xf bank_mask:0xf
    v_add_f32_dpp v139, v119, v118 row_ror:8 row_mask:0xf bank_mask:0xf
    v_add_f32_dpp v140, v121, v120 row_ror:8 row_mask:0xf bank_mask:0xf
    v_add_f32_dpp v141, v123, v122 row_ror:8 row_mask:0xf bank_mask:0xf
    v_add_f32_dpp v142, v125, v124 row_ror:8 row_mask:0xf bank_mask:0xf
    v_add_f32_dpp v143, v127, v126 row_ror:8 row_mask:0xf bank_mask:0xf
    v_permlane32_swap_b32 v128, v129
    v_permlane32_swap_b32 v130, v131
    v_permlane32_swap_b32 v132, v133
    v_permlane32_swap_b32 v134, v135
    v_permlane32_swap_b32 v136, v137
    v_permlane32_swap_b32 v138, v139
    v_permlane32_swap_b32 v140, v141
    v_permlane32_swap_b32 v142, v143
    v_add_f32 v144, v128, v129
    v_add_f32 v145, v130, v131
    v_add_f32 v146, v132, v133
    v_add_f32 v147, v134, v135
    v_add_f32 v148, v136, v137
    v_add_f32 v149, v138, v139
    v_add_f32 v150, v140, v141
    v_add_f32 v151, v142, v143
    s_mov_b32 exec_lo, 0xff00ff
    s_mov_b32 exec_hi, 0xff00ff
    ds_write_b128 v161, v[144:147] offset:15616
    ds_write_b128 v161, v[148:151] offset:15632
    s_mov_b64 exec, -1
    v_mov_b32 v8, 0
    v_mov_b32 v9, 1
    s_mov_b64 s[86:87], exec
    s_mov_b64 exec, 1
    ds_add_u32 v8, v9 offset:84
    s_mov_b64 exec, s[86:87]
    s_cmp_eq_u32 s21, 1
    s_cbranch_scc0 noQ_17
    v_bfe_u32 v8, v0, 4, 1
    v_lshlrev_b32 v8, 1, v8
    v_lshrrev_b32 v9, 5, v0
    v_add_u32 v8, v8, v9
    v_and_b32 v9, 7, v0
    v_lshrrev_b32 v10, 2, v9
    v_lshlrev_b32 v10, 4, v10
    v_and_b32 v9, 3, v9
    v_add_u32 v9, v9, v10
    s_and_b32 s24, s85, 1
    s_lshl_b32 s24, s24, 5
    s_lshr_b32 s25, s85, 1
    s_lshl_b32 s25, s25, 2
    s_add_u32 s24, s24, s25
    v_add_u32 v9, s24, v9
    v_lshlrev_b32 v9, 4, v9
    v_lshlrev_b32 v8, 11, v8
    v_add_u32 v8, v8, v9
    s_lshl_b32 s61, s16, 13
    s_add_u32 s61, s61, 212992
    v_mov_b32 v19, v3
    v_mov_b32 v21, v3
    v_mov_b32 v22, v3
    v_mov_b32 v23, v3
    v_mov_b32 v10, 0
spinw_20:
    ds_read_b32 v11, v10 offset:84
    ds_read_b128 v[32:35], v160 offset:15616
    ds_read_b128 v[36:39], v160 offset:15632
    ds_read_b128 v[40:43], v160 offset:16640
    ds_read_b128 v[44:47], v160 offset:16656
    ds_read_b128 v[48:51], v160 offset:17664
    ds_read_b128 v[52:55], v160 offset:17680
    ds_read_b128 v[56:59], v160 offset:18688
    ds_read_b128 v[60:63], v160 offset:18704
    s_waitcnt lgkmcnt(0)
    v_readfirstlane_b32 s24, v11
    s_nop 0
    s_cmp_ge_u32 s24, 4
    s_cbranch_scc1 spunw_21
    s_cmp_eq_u32 s80, 0
    s_cbranch_scc1 spunw_21
    s_sub_u32 s80, s80, 1
    s_branch spinw_20
spunw_21:
    v_pk_add_f32 v[32:33], v[32:33], v[40:41]
    v_pk_add_f32 v[34:35], v[34:35], v[42:43]
    v_pk_add_f32 v[36:37], v[36:37], v[44:45]
    v_pk_add_f32 v[38:39], v[38:39], v[46:47]
    v_pk_add_f32 v[48:49], v[48:49], v[56:57]
    v_pk_add_f32 v[50:51], v[50:51], v[58:59]
    v_pk_add_f32 v[52:53], v[52:53], v[60:61]
    v_pk_add_f32 v[54:55], v[54:55], v[62:63]
    v_pk_add_f32 v[32:33], v[32:33], v[48:49]
    v_pk_add_f32 v[34:35], v[34:35], v[50:51]
    v_pk_add_f32 v[36:37], v[36:37], v[52:53]
    v_pk_add_f32 v[38:39], v[38:39], v[54:55]
    v_cvt_pk_bf16_f32 v16, v32, v33
    v_cvt_pk_bf16_f32 v17, v34, v35
    v_cvt_pk_bf16_f32 v18, v36, v37
    v_cvt_pk_bf16_f32 v20, v38, v39
    s_mov_b32 exec_lo, 0xff00ff
    s_mov_b32 exec_hi, 0xff00ff
    buffer_store_dwordx4 v[16:19], v8, s[4:7], s61 offen
    buffer_store_dwordx4 v[20:23], v8, s[4:7], s61 offen offset:1024
    s_add_u32 s61, s61, 65536
    buffer_store_dwordx4 v[16:19], v8, s[4:7], s61 offen sc1
    buffer_store_dwordx4 v[20:23], v8, s[4:7], s61 offen offset:1024 sc1
    s_mov_b64 exec, -1
    v_mov_b32 v10, 0
    v_mov_b32 v11, 1
    s_mov_b64 s[86:87], exec
    s_mov_b64 exec, 1
    ds_write_b32 v10, v11 offset:48
    s_mov_b64 exec, s[86:87]
noQ_17:
    s_cmp_eq_u32 s21, 1
    s_cbranch_scc1 L_C1
    s_cmp_eq_u32 s21, 2
    s_cbranch_scc1 L_C2
    s_cmp_eq_u32 s21, 3
    s_cbranch_scc1 L_C3
    v_lshrrev_b32 v8, 4, v0
    v_bfe_u32 v9, v0, 3, 1
    v_lshrrev_b32 v10, 1, v8
    v_lshlrev_b32 v10, 5, v10
    v_and_b32 v8, 1, v8
    v_lshlrev_b32 v8, 2, v8
    v_add_u32 v8, v8, v10
    v_lshlrev_b32 v9, 1, v9
    v_add_u32 v8, v8, v9
    s_mov_b32 s24, 1024
    v_mul_lo_u32 v8, v8, s24
    v_and_b32 v9, 7, v0
    v_lshlrev_b32 v9, 4, v9
    v_add_u32 v2, v8, v9
    s_lshl_b32 s24, s16, 19
    s_lshl_b32 s25, s19, 17
    s_add_u32 s24, s24, s25
    s_lshl_b32 s25, s20, 7
    s_add_u32 s24, s24, s25
    s_mov_b32 s8, s40
    s_mov_b32 s9, s41
    s_add_u32 s8, s8, s24
    s_addc_u32 s9, s9, 0
    s_and_b32 s9, s9, 0xffff
    s_mov_b32 s10, 130176
    s_mov_b32 s11, 0x00020000
    v_lshrrev_b32 v8, 4, v0
    v_and_b32 v9, 15, v0
    v_lshlrev_b32 v10, 9, v8
    v_lshlrev_b32 v11, 5, v9
    v_add_u32 v10, v10, v11
    v_mov_b32 v13, s19
    v_bfe_u32 v11, v9, 1, 2
    v_lshlrev_b32 v12, 4, v11
    v_and_b32 v11, 8, v9
    v_add_u32 v12, v12, v11
    v_and_b32 v11, 1, v9
    v_add_u32 v12, v12, v11
    v_lshl_add_u32 v12, v13, 1, v12
    v_lshlrev_b32 v12, 4, v12
    v_mul_u32_u24 v8, 24576, v8
    v_add_u32 v12, v12, v8
    s_mul_i32 s28, s16, 98304
    s_add_u32 s28, s28, 589824
    s_mul_i32 s24, s20, 3072
    s_add_u32 s29, s24, s28
    v_lshlrev_b32 v13, 4, v0
    s_mov_b32 s64, 0xff00ff00
    s_mov_b32 s65, 0xff00ff00
    v_bfe_u32 v14, v0, 4, 1
    v_lshlrev_b32 v14, 1, v14
    v_lshrrev_b32 v151, 5, v0
    v_add_u32 v14, v14, v151
    v_and_b32 v151, 7, v0
    v_lshrrev_b32 v150, 1, v151
    v_mul_u32_u24 v150, 12288, v150
    v_and_b32 v151, 1, v151
    v_lshlrev_b32 v151, 2, v151
    v_add_u32 v151, v151, v14
    v_lshlrev_b32 v151, 4, v151
    v_add_u32 v14, v150, v151
    s_mul_i32 s62, s20, 49152
    s_mul_i32 s24, s16, 1536
    s_add_u32 s62, s62, s24
    s_mul_i32 s24, s19, 384
    s_add_u32 s62, s62, s24
    s_add_u32 s62, s62, 1376256
    v_mov_b32 v8, 0
spin_22:
    ds_read_b32 v9, v8 offset:40
    s_waitcnt lgkmcnt(0)
    v_readfirstlane_b32 s24, v9
    s_nop 0
    s_cmp_ge_u32 s24, 4
    s_cbranch_scc1 spun_23
    s_cmp_eq_u32 s80, 0
    s_cbranch_scc1 spun_23
    s_sub_u32 s80, s80, 1
    s_sleep 2
    s_branch spin_22
spun_23:
    buffer_load_dwordx4 v[96:99], v2, s[8:11], 0 offen offset:0 nt
    s_mov_b32 s84, 8192
    buffer_load_dwordx4 v[100:103], v2, s[8:11], s84 offen nt
    s_mov_b32 s84, 16384
    buffer_load_dwordx4 v[104:107], v2, s[8:11], s84 offen nt
    s_mov_b32 s84, 24576
    buffer_load_dwordx4 v[108:111], v2, s[8:11], s84 offen nt
    buffer_load_dwordx4 v[112:115], v2, s[8:11], 0 offen offset:1024 nt
    s_mov_b32 s84, 9216
    buffer_load_dwordx4 v[116:119], v2, s[8:11], s84 offen nt
    s_mov_b32 s84, 17408
    buffer_load_dwordx4 v[120:123], v2, s[8:11], s84 offen nt
    s_mov_b32 s84, 25600
    buffer_load_dwordx4 v[124:127], v2, s[8:11], s84 offen nt
    s_mov_b32 s84, 65536
    buffer_load_dwordx4 v[128:131], v2, s[8:11], s84 offen nt
    s_mov_b32 s84, 73728
    buffer_load_dwordx4 v[132:135], v2, s[8:11], s84 offen nt
    s_mov_b32 s84, 81920
    buffer_load_dwordx4 v[136:139], v2, s[8:11], s84 offen nt
    s_mov_b32 s84, 90112
    buffer_load_dwordx4 v[140:143], v2, s[8:11], s84 offen nt
    s_mov_b32 s84, 66560
    buffer_load_dwordx4 v[144:147], v2, s[8:11], s84 offen nt
    s_mov_b32 s84, 74752
    buffer_load_dwordx4 v[148:151], v2, s[8:11], s84 offen nt
    s_mov_b32 s84, 82944
    buffer_load_dwordx4 v[152:155], v2, s[8:11], s84 offen nt
    s_mov_b32 s84, 91136
    buffer_load_dwordx4 v[156:159], v2, s[8:11], s84 offen nt
    s_waitcnt vmcnt(8)
    v_perm_b32 v32, v100, v96, s70
    v_perm_b32 v36, v100, v96, s71
    v_perm_b32 v33, v108, v104, s70
    v_perm_b32 v37, v108, v104, s71
    v_perm_b32 v34, v116, v112, s70
    v_perm_b32 v38, v116, v112, s71
    v_perm_b32 v35, v124, v120, s70
    v_perm_b32 v39, v124, v120, s71
    v_perm_b32 v40, v101, v97, s70
    v_perm_b32 v44, v101, v97, s71
    v_perm_b32 v41, v109, v105, s70
    v_perm_b32 v45, v109, v105, s71
    v_perm_b32 v42, v117, v113, s70
    v_perm_b32 v46, v117, v113, s71
    v_perm_b32 v43, v125, v121, s70
    v_perm_b32 v47, v125, v121, s71
    v_perm_b32 v48, v102, v98, s70
    v_perm_b32 v52, v102, v98, s71
    v_perm_b32 v49, v110, v106, s70
    v_perm_b32 v53, v110, v106, s71
    v_perm_b32 v50, v118, v114, s70
    v_perm_b32 v54, v118, v114, s71
    v_perm_b32 v51, v126, v122, s70
    v_perm_b32 v55, v126, v122, s71
    v_perm_b32 v56, v103, v99, s70
    v_perm_b32 v60, v103, v99, s71
    v_perm_b32 v57, v111, v107, s70
    v_perm_b32 v61, v111, v107, s71
    v_perm_b32 v58, v119, v115, s70
    v_perm_b32 v62, v119, v115, s71
    v_perm_b32 v59, v127, v123, s70
    v_perm_b32 v63, v127, v123, s71
    s_waitcnt vmcnt(0)
    v_perm_b32 v64, v132, v128, s70
    v_perm_b32 v68, v132, v128, s71
    v_perm_b32 v65, v140, v136, s70
    v_perm_b32 v69, v140, v136, s71
    v_perm_b32 v66, v148, v144, s70
    v_perm_b32 v70, v148, v144, s71
    v_perm_b32 v67, v156, v152, s70
    v_perm_b32 v71, v156, v152, s71
    v_perm_b32 v72, v133, v129, s70
    v_perm_b32 v76, v133, v129, s71
    v_perm_b32 v73, v141, v137, s70
    v_perm_b32 v77, v141, v137, s71
    v_perm_b32 v74, v149, v145, s70
    v_perm_b32 v78, v149, v145, s71
    v_perm_b32 v75, v157, v153, s70
    v_perm_b32 v79, v157, v153, s71
    v_perm_b32 v80, v134, v130, s70
    v_perm_b32 v84, v134, v130, s71
    v_perm_b32 v81, v142, v138, s70
    v_perm_b32 v85, v142, v138, s71
    v_perm_b32 v82, v150, v146, s70
    v_perm_b32 v86, v150, v146, s71
    v_perm_b32 v83, v158, v154, s70
    v_perm_b32 v87, v158, v154, s71
    v_perm_b32 v88, v135, v131, s70
    v_perm_b32 v92, v135, v131, s71
    v_perm_b32 v89, v143, v139, s70
    v_perm_b32 v93, v143, v139, s71
    v_perm_b32 v90, v151, v147, s70
    v_perm_b32 v94, v151, v147, s71
    v_perm_b32 v91, v159, v155, s70
    v_perm_b32 v95, v159, v155, s71
    v_mov_b32 v1, 0
spin_24:
    ds_read_b32 v2, v1 offset:44
    s_waitcnt lgkmcnt(0)
    v_readfirstlane_b32 s24, v2
    s_nop 0
    s_cmp_ge_u32 s24, 1
    s_cbranch_scc1 spun_25
    s_cmp_eq_u32 s80, 0
    s_cbranch_scc1 spun_25
    s_sub_u32 s80, s80, 1
    s_sleep 1
    s_branch spin_24
spun_25:
    s_mov_b32 s22, s24
    v_mov_b32 v8, 0
spinw_26:
    ds_read_b32 v9, v8 offset:56
    ds_read_b128 v[96:99], v10 offset:7424
    ds_read_b128 v[100:103], v10 offset:7440
    ds_read_b128 v[104:107], v10 offset:9472
    ds_read_b128 v[108:111], v10 offset:9488
    ds_read_b128 v[112:115], v10 offset:11520
    ds_read_b128 v[116:119], v10 offset:11536
    ds_read_b128 v[120:123], v10 offset:13568
    ds_read_b128 v[124:127], v10 offset:13584
    s_waitcnt lgkmcnt(0)
    v_readfirstlane_b32 s24, v9
    s_nop 0
    s_cmp_ge_u32 s24, 4
    s_cbranch_scc1 spunw_27
    s_cmp_eq_u32 s80, 0
    s_cbranch_scc1 spunw_27
    s_sub_u32 s80, s80, 1
    s_branch spinw_26
spunw_27:
    v_pk_add_f32 v[96:97], v[96:97], v[104:105]
    v_pk_add_f32 v[98:99], v[98:99], v[106:107]
    v_pk_add_f32 v[100:101], v[100:101], v[108:109]
    v_pk_add_f32 v[102:103], v[102:103], v[110:111]
    v_pk_add_f32 v[112:113], v[112:113], v[120:121]
    v_pk_add_f32 v[114:115], v[114:115], v[122:123]
    v_pk_add_f32 v[116:117], v[116:117], v[124:125]
    v_pk_add_f32 v[118:119], v[118:119], v[126:127]
    v_pk_add_f32 v[96:97], v[96:97], v[112:113]
    v_pk_add_f32 v[98:99], v[98:99], v[114:115]
    v_pk_add_f32 v[100:101], v[100:101], v[116:117]
    v_pk_add_f32 v[102:103], v[102:103], v[118:119]
    v_mov_b32 v16, v96
    v_mov_b32 v17, v97
    v_mov_b32 v18, v98
    v_mov_b32 v20, v99
    v_mov_b32 v21, v100
    v_mov_b32 v22, v101
    v_mov_b32 v24, v102
    v_mov_b32 v25, v103
    v_mov_b32 v19, v3
    v_mov_b32 v23, v3
    v_mov_b32 v26, v3
    v_mov_b32 v27, v3
    s_cmp_eq_u32 s22, 1
    s_cbranch_scc0 slow_28
    buffer_store_dwordx4 v[16:19], v12, s[4:7], s29 offen offset:0
    buffer_store_dwordx4 v[20:23], v12, s[4:7], s29 offen offset:1024
    buffer_store_dwordx4 v[24:27], v12, s[4:7], s29 offen offset:2048
    s_branch st_done_29
slow_28:
    buffer_store_dwordx4 v[16:19], v12, s[4:7], s29 offen offset:0 sc1
    buffer_store_dwordx4 v[20:23], v12, s[4:7], s29 offen offset:1024 sc1
    buffer_store_dwordx4 v[24:27], v12, s[4:7], s29 offen offset:2048 sc1
st_done_29:
    v_mov_b32 v8, 0
    v_mov_b32 v9, 1
    s_mov_b64 s[86:87], exec
    s_mov_b64 exec, 1
    ds_write_b32 v8, v9 offset:92
    s_mov_b64 exec, s[86:87]
    v_mov_b32 v8, 0
spinw_30:
    ds_read_b32 v9, v8 offset:96
    ds_read_b128 v[4:7], v13 offset:256
    s_waitcnt lgkmcnt(0)
    v_readfirstlane_b32 s24, v9
    s_nop 0
    s_cmp_ge_u32 s24, 1
    s_cbranch_scc1 spunw_31
    s_cmp_eq_u32 s80, 0
    s_cbranch_scc1 spunw_31
    s_sub_u32 s80, s80, 1
    s_branch spinw_30
spunw_31:
    v_cndmask_b32 v16, v4, 0, s[64:65]
    v_cndmask_b32 v20, 0, v4, s[64:65]
    v_cndmask_b32 v17, v5, 0, s[64:65]
    v_cndmask_b32 v21, 0, v5, s[64:65]
    v_cndmask_b32 v18, v6, 0, s[64:65]
    v_cndmask_b32 v22, 0, v6, s[64:65]
    v_cndmask_b32 v19, v7, 0, s[64:65]
    v_cndmask_b32 v23, 0, v7, s[64:65]
    s_nop 0
    v_mfma_f32_16x16x32_bf16 v[96:99], v[16:19], v[32:35], 0
    v_mfma_f32_16x16x32_bf16 v[100:103], v[16:19], v[36:39], 0
    v_mfma_f32_16x16x32_bf16 v[104:107], v[16:19], v[40:43], 0
    v_mfma_f32_16x16x32_bf16 v[108:111], v[16:19], v[44:47], 0
    v_mfma_f32_16x16x32_bf16 v[112:115], v[16:19], v[48:51], 0
    v_mfma_f32_16x16x32_bf16 v[116:119], v[16:19], v[52:55], 0
    v_mfma_f32_16x16x32_bf16 v[120:123], v[16:19], v[56:59], 0
    v_mfma_f32_16x16x32_bf16 v[124:127], v[16:19], v[60:63], 0
    v_mfma_f32_16x16x32_bf16 v[96:99], v[20:23], v[64:67], v[96:99]
    v_mfma_f32_16x16x32_bf16 v[100:103], v[20:23], v[68:71], v[100:103]
    v_mfma_f32_16x16x32_bf16 v[104:107], v[20:23], v[72:75], v[104:107]
    v_mfma_f32_16x16x32_bf16 v[108:111], v[20:23], v[76:79], v[108:111]
    v_mfma_f32_16x16x32_bf16 v[112:115], v[20:23], v[80:83], v[112:115]
    v_mfma_f32_16x16x32_bf16 v[116:119], v[20:23], v[84:87], v[116:119]
    v_mfma_f32_16x16x32_bf16 v[120:123], v[20:23], v[88:91], v[120:123]
    v_mfma_f32_16x16x32_bf16 v[124:127], v[20:23], v[92:95], v[124:127]
    s_nop 0
    v_add_f32_dpp v128, v97, v96 row_ror:8 row_mask:0xf bank_mask:0xf
    v_add_f32_dpp v129, v99, v98 row_ror:8 row_mask:0xf bank_mask:0xf
    v_add_f32_dpp v130, v101, v100 row_ror:8 row_mask:0xf bank_mask:0xf
    v_add_f32_dpp v131, v103, v102 row_ror:8 row_mask:0xf bank_mask:0xf
    v_add_f32_dpp v132, v105, v104 row_ror:8 row_mask:0xf bank_mask:0xf
    v_add_f32_dpp v133, v107, v106 row_ror:8 row_mask:0xf bank_mask:0xf
    v_add_f32_dpp v134, v109, v108 row_ror:8 row_mask:0xf bank_mask:0xf
    v_add_f32_dpp v135, v111, v110 row_ror:8 row_mask:0xf bank_mask:0xf
    v_add_f32_dpp v136, v113, v112 row_ror:8 row_mask:0xf bank_mask:0xf
    v_add_f32_dpp v137, v115, v114 row_ror:8 row_mask:0xf bank_mask:0xf
    v_add_f32_dpp v138, v117, v116 row_ror:8 row_mask:0xf bank_mask:0xf
    v_add_f32_dpp v139, v119, v118 row_ror:8 row_mask:0xf bank_mask:0xf
    v_add_f32_dpp v140, v121, v120 row_ror:8 row_mask:0xf bank_mask:0xf
    v_add_f32_dpp v141, v123, v122 row_ror:8 row_mask:0xf bank_mask:0xf
    v_add_f32_dpp v142, v125, v124 row_ror:8 row_mask:0xf bank_mask:0xf
    v_add_f32_dpp v143, v127, v126 row_ror:8 row_mask:0xf bank_mask:0xf
    v_permlane32_swap_b32 v128, v129
    v_permlane32_swap_b32 v130, v131
    v_permlane32_swap_b32 v132, v133
    v_permlane32_swap_b32 v134, v135
    v_permlane32_swap_b32 v136, v137
    v_permlane32_swap_b32 v138, v139
    v_permlane32_swap_b32 v140, v141
    v_permlane32_swap_b32 v142, v143
    v_add_f32 v144, v128, v129
    v_add_f32 v145, v130, v131
    v_add_f32 v146, v132, v133
    v_add_f32 v148, v134, v135
    v_add_f32 v149, v136, v137
    v_add_f32 v150, v138, v139
    v_add_f32 v152, v140, v141
    v_add_f32 v153, v142, v143
    v_mov_b32 v147, v3
    v_mov_b32 v151, v3
    v_mov_b32 v154, v3
    v_mov_b32 v155, v3
    s_mov_b32 exec_lo, 0xff00ff
    s_mov_b32 exec_hi, 0xff00ff
    buffer_store_dwordx4 v[144:147], v14, s[4:7], s62 offen offset:0 sc1
    buffer_store_dwordx4 v[148:151], v14, s[4:7], s62 offen offset:128 sc1
    buffer_store_dwordx4 v[152:155], v14, s[4:7], s62 offen offset:256 sc1
    s_mov_b64 exec, -1
    s_waitcnt vmcnt(0)
    v_mov_b32 v8, 0
    v_mov_b32 v9, 1
    s_mov_b64 s[86:87], exec
    s_mov_b64 exec, 1
    ds_write_b32 v8, v9 offset:60
    s_mov_b64 exec, s[86:87]
    s_endpgm
L_C3:
    s_nop 4
    v_mov_b32 v8, 0
spin_32:
    ds_read_b32 v9, v8 offset:88
    s_waitcnt lgkmcnt(0)
    v_readfirstlane_b32 s24, v9
    s_nop 0
    s_cmp_ge_u32 s24, 4
    s_cbranch_scc1 spun_33
    s_cmp_eq_u32 s80, 0
    s_cbranch_scc1 spun_33
    s_sub_u32 s80, s80, 1
    s_sleep 4
    s_branch spin_32
spun_33:
    s_getreg_b32 s63, hwreg(HW_REG_XCC_ID, 0, 4)
    v_mov_b32 v11, v3
    s_mov_b32 s80, 24
    s_lshl_b32 s28, s16, 12
    s_add_u32 s28, s28, 32768
    v_and_b32 v12, 31, v0
    v_lshlrev_b32 v12, 7, v12
poll_34:
    buffer_load_dwordx4 v[16:19], v12, s[4:7], s28 offen sc1
    v_mov_b32 v9, 0
    s_waitcnt vmcnt(0)
    v_bitop3_b32 v9, v9, v19, s18 bitop3:0xf6
    v_cmp_ne_u32 s[82:83], 0, v9
    s_nop 0
    s_cmp_eq_u64 s[82:83], 0
    s_cbranch_scc1 polled_35
    s_cmp_eq_u32 s80, 0
    s_cbranch_scc1 polled_35
    s_sub_u32 s80, s80, 1
    s_sleep 8
    s_branch poll_34
polled_35:
    v_cmp_ne_u32 s[82:83], s63, v16
    v_cmp_ne_u32 s[24:25], v11, v19
    s_nop 0
    s_or_b64 s[82:83], s[82:83], s[24:25]
    s_cmp_eq_u64 s[82:83], 0
    s_cselect_b32 s22, 1, 2
    v_mov_b32 v8, s22
    v_mov_b32 v9, 0
    s_mov_b64 exec, 1
    ds_write_b32 v9, v8 offset:44
    s_mov_b64 exec, -1
    s_mov_b32 s80, 0x20000
    s_cmp_lt_u32 s16, 4
    s_cselect_b32 s61, 4, 3
    s_lshl_b32 s24, s16, 2
    s_mul_i32 s25, s16, 3
    s_add_u32 s25, s25, 4
    s_cmp_lt_u32 s16, 4
    s_cselect_b32 s62, s24, s25
    s_cmp_ge_u32 s19, s61
    s_cbranch_scc1 c3end_36
    v_lshrrev_b32 v8, 4, v0
    v_bfe_u32 v9, v0, 3, 1
    v_lshlrev_b32 v8, 4, v8
    v_lshlrev_b32 v9, 3, v9
    v_add_u32 v8, v8, v9
    s_mov_b32 s24, 1024
    v_mul_lo_u32 v8, v8, s24
    v_and_b32 v9, 7, v0
    v_lshlrev_b32 v9, 4, v9
    v_add_u32 v2, v8, v9
    s_add_u32 s24, s62, s19
    s_lshl_b32 s24, s24, 16
    s_lshl_b32 s25, s20, 7
    s_add_u32 s24, s24, s25
    s_mov_b32 s8, s48
    s_mov_b32 s9, s49
    s_add_u32 s8, s8, s24
    s_addc_u32 s9, s9, 0
    s_and_b32 s9, s9, 0xffff
    s_mov_b32 s10, 64640
    s_mov_b32 s11, 0x00020000
    v_lshlrev_b32 v13, 4, v0
    s_lshl_b32 s28, s16, 15
    s_lshl_b32 s24, s19, 13
    s_add_u32 s28, s28, s24
    s_add_u32 s28, s28, 1769472
    s_add_u32 s29, s28, 4096
    v_bfe_u32 v14, v0, 4, 1
    v_lshlrev_b32 v14, 1, v14
    v_lshrrev_b32 v151, 5, v0
    v_add_u32 v14, v14, v151
    v_and_b32 v151, 7, v0
    v_lshrrev_b32 v150, 1, v151
    v_lshlrev_b32 v150, 13, v150
    v_and_b32 v151, 1, v151
    v_lshlrev_b32 v151, 2, v151
    v_add_u32 v151, v151, v14
    v_lshlrev_b32 v151, 4, v151
    v_add_u32 v14, v150, v151
    s_lshl_b32 s62, s20, 15
    s_lshl_b32 s24, s16, 10
    s_add_u32 s62, s62, s24
    s_lshl_b32 s24, s19, 8
    s_add_u32 s62, s62, s24
    s_add_u32 s62, s62, 2031616
    v_mov_b32 v10, 0
spin_37:
    ds_read_b32 v11, v10 offset:96
    s_waitcnt lgkmcnt(0)
    v_readfirstlane_b32 s24, v11
    s_nop 0
    s_cmp_ge_u32 s24, 1
    s_cbranch_scc1 spun_38
    s_cmp_eq_u32 s80, 0
    s_cbranch_scc1 spun_38
    s_sub_u32 s80, s80, 1
    s_sleep 2
    s_branch spin_37
spun_38:
    buffer_load_dwordx4 v[64:67], v2, s[8:11], 0 offen offset:0 nt
    buffer_load_dwordx4 v[68:71], v2, s[8:11], 0 offen offset:1024 nt
    buffer_load_dwordx4 v[72:75], v2, s[8:11], 0 offen offset:2048 nt
    buffer_load_dwordx4 v[76:79], v2, s[8:11], 0 offen offset:3072 nt
    s_mov_b32 s84, 4096
    buffer_load_dwordx4 v[80:83], v2, s[8:11], s84 offen nt
    s_mov_b32 s84, 5120
    buffer_load_dwordx4 v[84:87], v2, s[8:11], s84 offen nt
    s_mov_b32 s84, 6144
    buffer_load_dwordx4 v[88:91], v2, s[8:11], s84 offen nt
    s_mov_b32 s84, 7168
    buffer_load_dwordx4 v[92:95], v2, s[8:11], s84 offen nt
    s_waitcnt vmcnt(0)
    v_perm_b32 v32, v68, v64, s70
    v_perm_b32 v36, v68, v64, s71
    v_perm_b32 v33, v76, v72, s70
    v_perm_b32 v37, v76, v72, s71
    v_perm_b32 v34, v84, v80, s70
    v_perm_b32 v38, v84, v80, s71
    v_perm_b32 v35, v92, v88, s70
    v_perm_b32 v39, v92, v88, s71
    v_perm_b32 v40, v69, v65, s70
    v_perm_b32 v44, v69, v65, s71
    v_perm_b32 v41, v77, v73, s70
    v_perm_b32 v45, v77, v73, s71
    v_perm_b32 v42, v85, v81, s70
    v_perm_b32 v46, v85, v81, s71
    v_perm_b32 v43, v93, v89, s70
    v_perm_b32 v47, v93, v89, s71
    v_perm_b32 v48, v70, v66, s70
    v_perm_b32 v52, v70, v66, s71
    v_perm_b32 v49, v78, v74, s70
    v_perm_b32 v53, v78, v74, s71
    v_perm_b32 v50, v86, v82, s70
    v_perm_b32 v54, v86, v82, s71
    v_perm_b32 v51, v94, v90, s70
    v_perm_b32 v55, v94, v90, s71
    v_perm_b32 v56, v71, v67, s70
    v_perm_b32 v60, v71, v67, s71
    v_perm_b32 v57, v79, v75, s70
    v_perm_b32 v61, v79, v75, s71
    v_perm_b32 v58, v87, v83, s70
    v_perm_b32 v62, v87, v83, s71
    v_perm_b32 v59, v95, v91, s70
    v_perm_b32 v63, v95, v91, s71
    v_mov_b32 v10, 0
spin_39:
    ds_read_b32 v11, v10 offset:68
    s_waitcnt lgkmcnt(0)
    v_readfirstlane_b32 s24, v11
    s_nop 0
    s_cmp_ge_u32 s24, 1
    s_cbranch_scc1 spun_40
    s_cmp_eq_u32 s80, 0
    s_cbranch_scc1 spun_40
    s_sub_u32 s80, s80, 1
    s_branch spin_39
spun_40:
poll_41:
    buffer_load_dwordx4 v[64:67], v13, s[4:7], s28 offen offset:0 sc1
    buffer_load_dwordx4 v[68:71], v13, s[4:7], s28 offen offset:1024 sc1
    buffer_load_dwordx4 v[72:75], v13, s[4:7], s28 offen offset:2048 sc1
    buffer_load_dwordx4 v[76:79], v13, s[4:7], s28 offen offset:3072 sc1
    buffer_load_dwordx4 v[80:83], v13, s[4:7], s29 offen offset:0 sc1
    buffer_load_dwordx4 v[84:87], v13, s[4:7], s29 offen offset:1024 sc1
    buffer_load_dwordx4 v[88:91], v13, s[4:7], s29 offen offset:2048 sc1
    buffer_load_dwordx4 v[92:95], v13, s[4:7], s29 offen offset:3072 sc1
    v_mov_b32 v9, 0
    s_waitcnt vmcnt(4)
    v_bitop3_b32 v9, v9, v64, s76 bitop3:0xf6
    v_bitop3_b32 v9, v9, v65, s77 bitop3:0xf6
    v_bitop3_b32 v9, v9, v66, s78 bitop3:0xf6
    v_bitop3_b32 v9, v9, v67, s79 bitop3:0xf6
    v_bitop3_b32 v9, v9, v68, s76 bitop3:0xf6
    v_bitop3_b32 v9, v9, v69, s77 bitop3:0xf6
    v_bitop3_b32 v9, v9, v70, s78 bitop3:0xf6
    v_bitop3_b32 v9, v9, v71, s79 bitop3:0xf6
    v_bitop3_b32 v9, v9, v72, s76 bitop3:0xf6
    v_bitop3_b32 v9, v9, v73, s77 bitop3:0xf6
    v_bitop3_b32 v9, v9, v74, s78 bitop3:0xf6
    v_bitop3_b32 v9, v9, v75, s79 bitop3:0xf6
    v_bitop3_b32 v9, v9, v76, s76 bitop3:0xf6
    v_bitop3_b32 v9, v9, v77, s77 bitop3:0xf6
    v_bitop3_b32 v9, v9, v78, s78 bitop3:0xf6
    v_bitop3_b32 v9, v9, v79, s79 bitop3:0xf6
    v_pk_add_f32 v[64:65], v[64:65], v[72:73]
    v_pk_add_f32 v[66:67], v[66:67], v[74:75]
    v_pk_add_f32 v[68:69], v[68:69], v[76:77]
    v_pk_add_f32 v[70:71], v[70:71], v[78:79]
    s_waitcnt vmcnt(0)
    v_bitop3_b32 v9, v9, v80, s76 bitop3:0xf6
    v_bitop3_b32 v9, v9, v81, s77 bitop3:0xf6
    v_bitop3_b32 v9, v9, v82, s78 bitop3:0xf6
    v_bitop3_b32 v9, v9, v83, s79 bitop3:0xf6
    v_bitop3_b32 v9, v9, v84, s76 bitop3:0xf6
    v_bitop3_b32 v9, v9, v85, s77 bitop3:0xf6
    v_bitop3_b32 v9, v9, v86, s78 bitop3:0xf6
    v_bitop3_b32 v9, v9, v87, s79 bitop3:0xf6
    v_bitop3_b32 v9, v9, v88, s76 bitop3:0xf6
    v_bitop3_b32 v9, v9, v89, s77 bitop3:0xf6
    v_bitop3_b32 v9, v9, v90, s78 bitop3:0xf6
    v_bitop3_b32 v9, v9, v91, s79 bitop3:0xf6
    v_bitop3_b32 v9, v9, v92, s76 bitop3:0xf6
    v_bitop3_b32 v9, v9, v93, s77 bitop3:0xf6
    v_bitop3_b32 v9, v9, v94, s78 bitop3:0xf6
    v_bitop3_b32 v9, v9, v95, s79 bitop3:0xf6
    v_pk_add_f32 v[80:81], v[80:81], v[88:89]
    v_pk_add_f32 v[82:83], v[82:83], v[90:91]
    v_pk_add_f32 v[84:85], v[84:85], v[92:93]
    v_pk_add_f32 v[86:87], v[86:87], v[94:95]
    v_and_b32 v9, 0xff, v9
    v_cmp_ne_u32 s[82:83], 0, v9
    s_nop 0
    s_cmp_eq_u64 s[82:83], 0
    s_cbranch_scc1 polled_42
    s_cmp_eq_u32 s80, 0
    s_cbranch_scc1 polled_42
    s_sub_u32 s80, s80, 1
    s_branch poll_41
polled_42:
    v_pk_add_f32 v[64:65], v[64:65], v[80:81]
    v_pk_add_f32 v[66:67], v[66:67], v[82:83]
    v_pk_add_f32 v[68:69], v[68:69], v[84:85]
    v_pk_add_f32 v[70:71], v[70:71], v[86:87]
    v_cvt_pk_bf16_f32 v16, v64, v65
    v_lshlrev_b32 v64, 16, v16
    v_and_b32 v65, s88, v16
    v_cvt_pk_bf16_f32 v17, v66, v67
    v_lshlrev_b32 v66, 16, v17
    v_and_b32 v67, s88, v17
    v_cvt_pk_bf16_f32 v16, v68, v69
    v_lshlrev_b32 v68, 16, v16
    v_and_b32 v69, s88, v16
    v_cvt_pk_bf16_f32 v17, v70, v71
    v_lshlrev_b32 v70, 16, v17
    v_and_b32 v71, s88, v17
    v_mul_f32 v72, s89, v64
    v_mul_f32 v73, s89, v65
    v_mul_f32 v74, s89, v66
    v_mul_f32 v75, s89, v67
    v_mul_f32 v76, s89, v68
    v_mul_f32 v77, s89, v69
    v_mul_f32 v78, s89, v70
    v_mul_f32 v79, s89, v71
    v_exp_f32 v72, -v72
    v_exp_f32 v73, -v73
    v_exp_f32 v74, -v74
    v_exp_f32 v75, -v75
    v_exp_f32 v76, -v76
    v_exp_f32 v77, -v77
    v_exp_f32 v78, -v78
    v_exp_f32 v79, -v79
    v_add_f32 v72, 1.0, v72
    v_add_f32 v73, 1.0, v73
    v_add_f32 v74, 1.0, v74
    v_add_f32 v75, 1.0, v75
    v_add_f32 v76, 1.0, v76
    v_add_f32 v77, 1.0, v77
    v_add_f32 v78, 1.0, v78
    v_add_f32 v79, 1.0, v79
    v_rcp_f32 v72, v72
    v_rcp_f32 v73, v73
    v_rcp_f32 v74, v74
    v_rcp_f32 v75, v75
    v_rcp_f32 v76, v76
    v_rcp_f32 v77, v77
    v_rcp_f32 v78, v78
    v_rcp_f32 v79, v79
    v_pk_mul_f32 v[72:73], v[72:73], v[64:65]
    v_pk_mul_f32 v[74:75], v[74:75], v[66:67]
    v_pk_mul_f32 v[76:77], v[76:77], v[68:69]
    v_pk_mul_f32 v[78:79], v[78:79], v[70:71]
    v_cvt_pk_bf16_f32 v16, v72, v73
    v_lshlrev_b32 v72, 16, v16
    v_and_b32 v73, s88, v16
    v_cvt_pk_bf16_f32 v17, v74, v75
    v_lshlrev_b32 v74, 16, v17
    v_and_b32 v75, s88, v17
    v_cvt_pk_bf16_f32 v16, v76, v77
    v_lshlrev_b32 v76, 16, v16
    v_and_b32 v77, s88, v16
    v_cvt_pk_bf16_f32 v17, v78, v79
    v_lshlrev_b32 v78, 16, v17
    v_and_b32 v79, s88, v17
    v_mul_f32_dpp v72, v64, v72 row_ror:8 row_mask:0xf bank_mask:0xf
    v_mul_f32_dpp v73, v65, v73 row_ror:8 row_mask:0xf bank_mask:0xf
    v_mul_f32_dpp v74, v66, v74 row_ror:8 row_mask:0xf bank_mask:0xf
    v_mul_f32_dpp v75, v67, v75 row_ror:8 row_mask:0xf bank_mask:0xf
    v_mul_f32_dpp v76, v68, v76 row_ror:8 row_mask:0xf bank_mask:0xf
    v_mul_f32_dpp v77, v69, v77 row_ror:8 row_mask:0xf bank_mask:0xf
    v_mul_f32_dpp v78, v70, v78 row_ror:8 row_mask:0xf bank_mask:0xf
    v_mul_f32_dpp v79, v71, v79 row_ror:8 row_mask:0xf bank_mask:0xf
    v_cvt_pk_bf16_f32 v4, v72, v73
    v_cvt_pk_bf16_f32 v5, v74, v75
    v_cvt_pk_bf16_f32 v6, v76, v77
    v_cvt_pk_bf16_f32 v7, v78, v79
    s_nop 1
    v_mfma_f32_16x16x32_bf16 v[96:99], v[4:7], v[32:35], 0
    v_mfma_f32_16x16x32_bf16 v[100:103], v[4:7], v[36:39], 0
    v_mfma_f32_16x16x32_bf16 v[104:107], v[4:7], v[40:43], 0
    v_mfma_f32_16x16x32_bf16 v[108:111], v[4:7], v[44:47], 0
    v_mfma_f32_16x16x32_bf16 v[112:115], v[4:7], v[48:51], 0
    v_mfma_f32_16x16x32_bf16 v[116:119], v[4:7], v[52:55], 0
    v_mfma_f32_16x16x32_bf16 v[120:123], v[4:7], v[56:59], 0
    v_mfma_f32_16x16x32_bf16 v[124:127], v[4:7], v[60:63], 0
    s_nop 0
    v_add_f32_dpp v128, v97, v96 row_ror:8 row_mask:0xf bank_mask:0xf
    v_add_f32_dpp v129, v99, v98 row_ror:8 row_mask:0xf bank_mask:0xf
    v_add_f32_dpp v130, v101, v100 row_ror:8 row_mask:0xf bank_mask:0xf
    v_add_f32_dpp v131, v103, v102 row_ror:8 row_mask:0xf bank_mask:0xf
    v_add_f32_dpp v132, v105, v104 row_ror:8 row_mask:0xf bank_mask:0xf
    v_add_f32_dpp v133, v107, v106 row_ror:8 row_mask:0xf bank_mask:0xf
    v_add_f32_dpp v134, v109, v108 row_ror:8 row_mask:0xf bank_mask:0xf
    v_add_f32_dpp v135, v111, v110 row_ror:8 row_mask:0xf bank_mask:0xf
    v_add_f32_dpp v136, v113, v112 row_ror:8 row_mask:0xf bank_mask:0xf
    v_add_f32_dpp v137, v115, v114 row_ror:8 row_mask:0xf bank_mask:0xf
    v_add_f32_dpp v138, v117, v116 row_ror:8 row_mask:0xf bank_mask:0xf
    v_add_f32_dpp v139, v119, v118 row_ror:8 row_mask:0xf bank_mask:0xf
    v_add_f32_dpp v140, v121, v120 row_ror:8 row_mask:0xf bank_mask:0xf
    v_add_f32_dpp v141, v123, v122 row_ror:8 row_mask:0xf bank_mask:0xf
    v_add_f32_dpp v142, v125, v124 row_ror:8 row_mask:0xf bank_mask:0xf
    v_add_f32_dpp v143, v127, v126 row_ror:8 row_mask:0xf bank_mask:0xf
    v_permlane32_swap_b32 v128, v129
    v_permlane32_swap_b32 v130, v131
    v_permlane32_swap_b32 v132, v133
    v_permlane32_swap_b32 v134, v135
    v_permlane32_swap_b32 v136, v137
    v_permlane32_swap_b32 v138, v139
    v_permlane32_swap_b32 v140, v141
    v_permlane32_swap_b32 v142, v143
    v_mov_b32 v144, v128
    v_mov_b32 v145, v130
    v_mov_b32 v146, v132
    v_mov_b32 v147, v134
    v_mov_b32 v148, v136
    v_mov_b32 v149, v138
    v_mov_b32 v150, v140
    v_mov_b32 v151, v142
    v_perm_b32 v16, v144, v3, s72
    v_perm_b32 v17, v145, v3, s73
    v_perm_b32 v18, v146, v3, s74
    v_perm_b32 v19, v147, v3, s75
    v_perm_b32 v20, v148, v3, s72
    v_perm_b32 v21, v149, v3, s73
    v_perm_b32 v22, v150, v3, s74
    v_perm_b32 v23, v151, v3, s75
    s_mov_b32 exec_lo, 0xff00ff
    s_mov_b32 exec_hi, 0xff00ff
    buffer_store_dwordx4 v[16:19], v14, s[4:7], s62 offen sc1
    buffer_store_dwordx4 v[20:23], v14, s[4:7], s62 offen offset:128 sc1
    s_mov_b64 exec, -1
    s_waitcnt vmcnt(0)
    v_mov_b32 v8, 0
    v_mov_b32 v9, 1
    s_mov_b64 s[86:87], exec
    s_mov_b64 exec, 1
    ds_write_b32 v8, v9 offset:72
    s_mov_b64 exec, s[86:87]
    s_endpgm
c3end_36:
    v_mov_b32 v8, 0
spin_43:
    ds_read_b32 v9, v8 offset:68
    s_waitcnt lgkmcnt(0)
    v_readfirstlane_b32 s24, v9
    s_nop 0
    s_cmp_ge_u32 s24, 1
    s_cbranch_scc1 spun_44
    s_cmp_eq_u32 s80, 0
    s_cbranch_scc1 spun_44
    s_sub_u32 s80, s80, 1
    s_sleep 8
    s_branch spin_43
spun_44:
    v_mov_b32 v8, 0
    v_mov_b32 v9, 1
    s_mov_b64 s[86:87], exec
    s_mov_b64 exec, 1
    ds_write_b32 v8, v9 offset:72
    s_mov_b64 exec, s[86:87]
    s_endpgm
L_C1:
    s_nop 4
    s_cmp_lt_u32 s16, 4
    s_cselect_b32 s61, 4, 3
    s_lshl_b32 s24, s16, 2
    s_mul_i32 s25, s16, 3
    s_add_u32 s25, s25, 4
    s_cmp_lt_u32 s16, 4
    s_cselect_b32 s62, s24, s25
    s_and_b32 s63, s17, 3
    s_cmp_ge_u32 s63, s61
    s_cbranch_scc1 c1end_45
    v_mov_b32 v10, 0
spin_46:
    ds_read_b32 v11, v10 offset:88
    s_waitcnt lgkmcnt(0)
    v_readfirstlane_b32 s24, v11
    s_nop 0
    s_cmp_ge_u32 s24, 4
    s_cbranch_scc1 spun_47
    s_cmp_eq_u32 s80, 0
    s_cbranch_scc1 spun_47
    s_sub_u32 s80, s80, 1
    s_sleep 4
    s_branch spin_46
spun_47:
    v_bfe_u32 v10, v0, 1, 2
    v_lshrrev_b32 v11, 4, v0
    v_lshlrev_b32 v11, 1, v11
    v_and_b32 v1, 1, v0
    v_add_u32 v11, v11, v1
    v_and_b32 v1, 8, v0
    v_add_u32 v11, v11, v1
    v_lshlrev_b32 v8, 4, v0
    s_mul_i32 s28, s19, 3072
    s_add_u32 s28, s28, 102400
    s_mul_i32 s29, s19, 3072
    s_add_u32 s29, s29, 176128
    s_mul_i32 s30, s19, 3072
    s_add_u32 s30, s30, 114688
    s_mul_i32 s31, s19, 3072
    s_add_u32 s31, s31, 188416
poll_48:
    buffer_load_dwordx4 v[96:99], v8, s[4:7], s28 offen offset:0 sc1
    buffer_load_dwordx4 v[100:103], v8, s[4:7], s28 offen offset:1024 sc1
    buffer_load_dwordx4 v[104:107], v8, s[4:7], s28 offen offset:2048 sc1
    buffer_load_dwordx4 v[108:111], v8, s[4:7], s29 offen offset:0 sc1
    buffer_load_dwordx4 v[112:115], v8, s[4:7], s29 offen offset:1024 sc1
    buffer_load_dwordx4 v[116:119], v8, s[4:7], s29 offen offset:2048 sc1
    buffer_load_dwordx4 v[120:123], v8, s[4:7], s30 offen offset:0 sc1
    buffer_load_dwordx4 v[124:127], v8, s[4:7], s30 offen offset:1024 sc1
    buffer_load_dwordx4 v[128:131], v8, s[4:7], s30 offen offset:2048 sc1
    buffer_load_dwordx4 v[132:135], v8, s[4:7], s31 offen offset:0 sc1
    buffer_load_dwordx4 v[136:139], v8, s[4:7], s31 offen offset:1024 sc1
    buffer_load_dwordx4 v[140:143], v8, s[4:7], s31 offen offset:2048 sc1
    v_mov_b32 v9, 0
    s_waitcnt vmcnt(0)
    v_bitop3_b32 v9, v9, v99, s18 bitop3:0xf6
    v_bitop3_b32 v9, v9, v103, s18 bitop3:0xf6
    v_bitop3_b32 v9, v9, v107, s18 bitop3:0xf6
    v_bitop3_b32 v9, v9, v111, s18 bitop3:0xf6
    v_bitop3_b32 v9, v9, v115, s18 bitop3:0xf6
    v_bitop3_b32 v9, v9, v119, s18 bitop3:0xf6
    v_bitop3_b32 v9, v9, v123, s18 bitop3:0xf6
    v_bitop3_b32 v9, v9, v127, s18 bitop3:0xf6
    v_bitop3_b32 v9, v9, v131, s18 bitop3:0xf6
    v_bitop3_b32 v9, v9, v135, s18 bitop3:0xf6
    v_bitop3_b32 v9, v9, v139, s18 bitop3:0xf6
    v_bitop3_b32 v9, v9, v143, s18 bitop3:0xf6
    v_cmp_ne_u32 s[82:83], 0, v9
    s_nop 0
    s_cmp_eq_u64 s[82:83], 0
    s_cbranch_scc1 polled_49
    s_cmp_eq_u32 s80, 0
    s_cbranch_scc1 polled_49
    s_sub_u32 s80, s80, 1
    s_sleep 8
    s_branch poll_48
polled_49:
    v_pk_add_f32 v[16:17], v[96:97], v[108:109]
    v_add_f32 v18, v98, v110
    v_add_f32 v19, v100, v112
    v_add_f32 v20, v101, v113
    v_add_f32 v21, v102, v114
    v_pk_add_f32 v[22:23], v[104:105], v[116:117]
    v_pk_add_f32 v[24:25], v[120:121], v[132:133]
    v_add_f32 v26, v122, v134
    v_add_f32 v27, v124, v136
    v_add_f32 v28, v125, v137
    v_add_f32 v29, v126, v138
    v_pk_add_f32 v[30:31], v[128:129], v[140:141]
    v_cvt_pk_bf16_f32 v14, v16, v17
    v_lshlrev_b32 v16, 16, v14
    v_and_b32 v17, s88, v14
    v_cvt_pk_bf16_f32 v15, v18, v19
    v_lshlrev_b32 v18, 16, v15
    v_and_b32 v19, s88, v15
    v_cvt_pk_bf16_f32 v14, v20, v21
    v_lshlrev_b32 v20, 16, v14
    v_and_b32 v21, s88, v14
    v_cvt_pk_bf16_f32 v15, v22, v23
    v_lshlrev_b32 v22, 16, v15
    v_and_b32 v23, s88, v15
    v_cvt_pk_bf16_f32 v14, v24, v25
    v_lshlrev_b32 v24, 16, v14
    v_and_b32 v25, s88, v14
    v_cvt_pk_bf16_f32 v15, v26, v27
    v_lshlrev_b32 v26, 16, v15
    v_and_b32 v27, s88, v15
    v_cvt_pk_bf16_f32 v14, v28, v29
    v_lshlrev_b32 v28, 16, v14
    v_and_b32 v29, s88, v14
    v_cvt_pk_bf16_f32 v15, v30, v31
    v_lshlrev_b32 v30, 16, v15
    v_and_b32 v31, s88, v15
    v_add_f32 v24, 1.0, v24
    v_add_f32 v25, 1.0, v25
    v_add_f32 v26, 1.0, v26
    v_add_f32 v27, 1.0, v27
    v_add_f32 v28, 1.0, v28
    v_add_f32 v29, 1.0, v29
    v_add_f32 v30, 1.0, v30
    v_add_f32 v31, 1.0, v31
    v_cvt_pk_bf16_f32 v14, v24, v25
    v_lshlrev_b32 v24, 16, v14
    v_and_b32 v25, s88, v14
    v_cvt_pk_bf16_f32 v15, v26, v27
    v_lshlrev_b32 v26, 16, v15
    v_and_b32 v27, s88, v15
    v_cvt_pk_bf16_f32 v14, v28, v29
    v_lshlrev_b32 v28, 16, v14
    v_and_b32 v29, s88, v14
    v_cvt_pk_bf16_f32 v15, v30, v31
    v_lshlrev_b32 v30, 16, v15
    v_and_b32 v31, s88, v15
    v_lshrrev_b32 v144, 4, v0
    v_bfe_u32 v145, v0, 3, 1
    v_lshlrev_b32 v144, 4, v144
    v_lshlrev_b32 v145, 3, v145
    v_add_u32 v144, v144, v145
    s_mov_b32 s24, 3584
    v_mul_lo_u32 v144, v144, s24
    v_and_b32 v145, 7, v0
    v_lshlrev_b32 v145, 4, v145
    v_add_u32 v2, v144, v145
    s_mul_i32 s24, s19, 458752
    s_add_u32 s25, s62, s63
    s_lshl_b32 s25, s25, 7
    s_add_u32 s24, s24, s25
    s_bitcmp1_b32 s17, 2
    s_cselect_b32 s26, s46, s44
    s_cselect_b32 s27, s47, s45
    s_mov_b32 s8, s26
    s_mov_b32 s9, s27
    s_add_u32 s8, s8, s24
    s_addc_u32 s9, s9, 0
    s_and_b32 s9, s9, 0xffff
    s_mov_b32 s10, 455296
    s_mov_b32 s11, 0x00020000
    v_lshlrev_b32 v8, 4, v0
    v_and_b32 v12, 3, v11
    v_lshlrev_b32 v12, 11, v12
    v_lshrrev_b32 v13, 2, v11
    v_lshl_add_u32 v13, v10, 4, v13
    s_lshl_b32 s24, s19, 2
    v_add_u32 v13, s24, v13
    v_lshlrev_b32 v13, 4, v13
    v_add_u32 v12, v12, v13
    s_lshl_b32 s28, s16, 13
    s_add_u32 s28, s28, 475136
    s_lshl_b32 s29, s16, 12
    s_add_u32 s29, s29, 540672
    v_bfe_u32 v14, v0, 4, 1
    v_lshlrev_b32 v14, 1, v14
    v_lshrrev_b32 v15, 5, v0
    v_add_u32 v14, v14, v15
    v_and_b32 v15, 7, v0
    v_lshrrev_b32 v13, 1, v15
    v_lshlrev_b32 v13, 4, v13
    v_and_b32 v15, 1, v15
    v_add_u32 v13, v13, v15
    v_lshl_add_u32 v13, v14, 1, v13
    s_lshl_b32 s24, s17, 1
    s_and_b32 s24, s24, 8
    v_add_u32 v13, s24, v13
    v_lshlrev_b32 v14, 4, v13
    s_lshl_b32 s62, s16, 15
    s_lshl_b32 s24, s63, 13
    s_add_u32 s62, s62, s24
    s_lshl_b32 s24, s19, 11
    s_add_u32 s62, s62, s24
    s_add_u32 s62, s62, 1769472
    s_mov_b32 s64, 0xff00ff00
    s_mov_b32 s65, 0xff00ff00
    v_lshlrev_b32 v15, 6, v10
    v_mov_b32 v4, 0
spin_50:
    ds_read_b32 v5, v4 offset:96
    s_waitcnt lgkmcnt(0)
    v_readfirstlane_b32 s24, v5
    s_nop 0
    s_cmp_ge_u32 s24, 1
    s_cbranch_scc1 spun_51
    s_cmp_eq_u32 s80, 0
    s_cbranch_scc1 spun_51
    s_sub_u32 s80, s80, 1
    s_sleep 2
    s_branch spin_50
spun_51:
    buffer_load_dwordx4 v[96:99], v2, s[8:11], 0 offen offset:0 nt
    buffer_load_dwordx4 v[100:103], v2, s[8:11], 0 offen offset:3584 nt
    s_mov_b32 s84, 7168
    buffer_load_dwordx4 v[104:107], v2, s[8:11], s84 offen nt
    s_mov_b32 s84, 10752
    buffer_load_dwordx4 v[108:111], v2, s[8:11], s84 offen nt
    s_mov_b32 s84, 14336
    buffer_load_dwordx4 v[112:115], v2, s[8:11], s84 offen nt
    s_mov_b32 s84, 17920
    buffer_load_dwordx4 v[116:119], v2, s[8:11], s84 offen nt
    s_mov_b32 s84, 21504
    buffer_load_dwordx4 v[120:123], v2, s[8:11], s84 offen nt
    s_mov_b32 s84, 25088
    buffer_load_dwordx4 v[124:127], v2, s[8:11], s84 offen nt
    s_mov_b32 s84, 229376
    buffer_load_dwordx4 v[128:131], v2, s[8:11], s84 offen nt
    s_mov_b32 s84, 232960
    buffer_load_dwordx4 v[132:135], v2, s[8:11], s84 offen nt
    s_mov_b32 s84, 236544
    buffer_load_dwordx4 v[136:139], v2, s[8:11], s84 offen nt
    s_mov_b32 s84, 240128
    buffer_load_dwordx4 v[140:143], v2, s[8:11], s84 offen nt
    s_mov_b32 s84, 243712
    buffer_load_dwordx4 v[144:147], v2, s[8:11], s84 offen nt
    s_mov_b32 s84, 247296
    buffer_load_dwordx4 v[148:151], v2, s[8:11], s84 offen nt
    s_mov_b32 s84, 250880
    buffer_load_dwordx4 v[152:155], v2, s[8:11], s84 offen nt
    s_mov_b32 s84, 254464
    buffer_load_dwordx4 v[156:159], v2, s[8:11], s84 offen nt
    s_waitcnt vmcnt(8)
    v_perm_b32 v32, v100, v96, s70
    v_perm_b32 v36, v100, v96, s71
    v_perm_b32 v33, v108, v104, s70
    v_perm_b32 v37, v108, v104, s71
    v_perm_b32 v34, v116, v112, s70
    v_perm_b32 v38, v116, v112, s71
    v_perm_b32 v35, v124, v120, s70
    v_perm_b32 v39, v124, v120, s71
    v_perm_b32 v40, v101, v97, s70
    v_perm_b32 v44, v101, v97, s71
    v_perm_b32 v41, v109, v105, s70
    v_perm_b32 v45, v109, v105, s71
    v_perm_b32 v42, v117, v113, s70
    v_perm_b32 v46, v117, v113, s71
    v_perm_b32 v43, v125, v121, s70
    v_perm_b32 v47, v125, v121, s71
    v_perm_b32 v48, v102, v98, s70
    v_perm_b32 v52, v102, v98, s71
    v_perm_b32 v49, v110, v106, s70
    v_perm_b32 v53, v110, v106, s71
    v_perm_b32 v50, v118, v114, s70
    v_perm_b32 v54, v118, v114, s71
    v_perm_b32 v51, v126, v122, s70
    v_perm_b32 v55, v126, v122, s71
    v_perm_b32 v56, v103, v99, s70
    v_perm_b32 v60, v103, v99, s71
    v_perm_b32 v57, v111, v107, s70
    v_perm_b32 v61, v111, v107, s71
    v_perm_b32 v58, v119, v115, s70
    v_perm_b32 v62, v119, v115, s71
    v_perm_b32 v59, v127, v123, s70
    v_perm_b32 v63, v127, v123, s71
    s_waitcnt vmcnt(0)
    v_perm_b32 v64, v132, v128, s70
    v_perm_b32 v68, v132, v128, s71
    v_perm_b32 v65, v140, v136, s70
    v_perm_b32 v69, v140, v136, s71
    v_perm_b32 v66, v148, v144, s70
    v_perm_b32 v70, v148, v144, s71
    v_perm_b32 v67, v156, v152, s70
    v_perm_b32 v71, v156, v152, s71
    v_perm_b32 v72, v133, v129, s70
    v_perm_b32 v76, v133, v129, s71
    v_perm_b32 v73, v141, v137, s70
    v_perm_b32 v77, v141, v137, s71
    v_perm_b32 v74, v149, v145, s70
    v_perm_b32 v78, v149, v145, s71
    v_perm_b32 v75, v157, v153, s70
    v_perm_b32 v79, v157, v153, s71
    v_perm_b32 v80, v134, v130, s70
    v_perm_b32 v84, v134, v130, s71
    v_perm_b32 v81, v142, v138, s70
    v_perm_b32 v85, v142, v138, s71
    v_perm_b32 v82, v150, v146, s70
    v_perm_b32 v86, v150, v146, s71
    v_perm_b32 v83, v158, v154, s70
    v_perm_b32 v87, v158, v154, s71
    v_perm_b32 v88, v135, v131, s70
    v_perm_b32 v92, v135, v131, s71
    v_perm_b32 v89, v143, v139, s70
    v_perm_b32 v93, v143, v139, s71
    v_perm_b32 v90, v151, v147, s70
    v_perm_b32 v94, v151, v147, s71
    v_perm_b32 v91, v159, v155, s70
    v_perm_b32 v95, v159, v155, s71
    v_mov_b32 v1, 0
spin_52:
    ds_read_b32 v2, v1 offset:44
    s_waitcnt lgkmcnt(0)
    v_readfirstlane_b32 s24, v2
    s_nop 0
    s_cmp_ge_u32 s24, 1
    s_cbranch_scc1 spun_53
    s_cmp_eq_u32 s80, 0
    s_cbranch_scc1 spun_53
    s_sub_u32 s80, s80, 1
    s_sleep 1
    s_branch spin_52
spun_53:
    s_mov_b32 s22, s24
    v_mov_b32 v4, 0
spin_54:
    ds_read_b32 v5, v4 offset:64
    s_waitcnt lgkmcnt(0)
    v_readfirstlane_b32 s24, v5
    s_nop 0
    s_cmp_ge_u32 s24, 1
    s_cbranch_scc1 spun_55
    s_cmp_eq_u32 s80, 0
    s_cbranch_scc1 spun_55
    s_sub_u32 s80, s80, 1
    s_branch spin_54
spun_55:
poll_56:
    buffer_load_dwordx4 v[96:99], v8, s[4:7], s29 offen offset:0 sc1
    buffer_load_dwordx4 v[100:103], v8, s[4:7], s29 offen offset:1024 sc1
    buffer_load_dwordx4 v[104:107], v8, s[4:7], s29 offen offset:2048 sc1
    buffer_load_dwordx4 v[108:111], v8, s[4:7], s29 offen offset:3072 sc1
    buffer_load_dwordx4 v[128:131], v12, s[4:7], s28 offen offset:0 sc1
    buffer_load_dwordx4 v[132:135], v12, s[4:7], s28 offen offset:1024 sc1
    v_mov_b32 v9, 0
    s_waitcnt vmcnt(0)
    v_bitop3_b32 v9, v9, v128, s76 bitop3:0xf6
    v_bitop3_b32 v9, v9, v129, s77 bitop3:0xf6
    v_bitop3_b32 v9, v9, v130, s78 bitop3:0xf6
    v_bitop3_b32 v9, v9, v131, s79 bitop3:0xf6
    v_bitop3_b32 v9, v9, v132, s76 bitop3:0xf6
    v_bitop3_b32 v9, v9, v133, s77 bitop3:0xf6
    v_bitop3_b32 v9, v9, v134, s78 bitop3:0xf6
    v_bitop3_b32 v9, v9, v135, s79 bitop3:0xf6
    v_and_b32 v9, 0xff, v9
    v_bitop3_b32 v9, v9, v99, s18 bitop3:0xf6
    v_bitop3_b32 v9, v9, v103, s18 bitop3:0xf6
    v_bitop3_b32 v9, v9, v107, s18 bitop3:0xf6
    v_bitop3_b32 v9, v9, v111, s18 bitop3:0xf6
    v_cmp_ne_u32 s[82:83], 0, v9
    s_nop 0
    s_cmp_eq_u64 s[82:83], 0
    s_cbranch_scc1 polled_57
    s_cmp_eq_u32 s80, 0
    s_cbranch_scc1 polled_57
    s_sub_u32 s80, s80, 1
    s_branch poll_56
polled_57:
    v_add_f32 v112, v96, v100
    v_add_f32 v113, v104, v108
    v_add_f32 v114, v97, v101
    v_add_f32 v115, v105, v109
    v_add_f32 v112, v112, v113
    v_add_f32 v114, v114, v115
    v_and_b32 v128, s88, v128
    v_and_b32 v129, s88, v129
    v_and_b32 v130, s88, v130
    v_and_b32 v131, s88, v131
    v_and_b32 v132, s88, v132
    v_and_b32 v133, s88, v133
    v_and_b32 v134, s88, v134
    v_and_b32 v135, s88, v135
    v_add_f32_dpp v112, v112, v112 row_ror:8 row_mask:0xf bank_mask:0xf
    s_nop 1
    v_add_f32_dpp v112, v112, v112 row_ror:4 row_mask:0xf bank_mask:0xf
    s_nop 1
    v_add_f32_dpp v112, v112, v112 row_ror:2 row_mask:0xf bank_mask:0xf
    s_nop 1
    v_add_f32_dpp v112, v112, v112 row_ror:1 row_mask:0xf bank_mask:0xf
    v_mul_f32 v113, 0x3b000000, v112
    v_mul_f32 v116, 0x3e000000, v96
    v_mul_f32 v117, 0x3e000000, v100
    v_mul_f32 v118, 0x3e000000, v104
    v_mul_f32 v119, 0x3e000000, v108
    v_sub_f32 v116, v116, v113
    v_sub_f32 v117, v117, v113
    v_sub_f32 v118, v118, v113
    v_sub_f32 v119, v119, v113
    v_mul_f32 v116, v116, v116
    v_mul_f32 v117, v117, v117
    v_mul_f32 v118, v118, v118
    v_mul_f32 v119, v119, v119
    v_add_f32 v116, v116, v117
    v_add_f32 v118, v118, v119
    v_add_f32 v116, v116, v118
    v_mul_f32 v116, 0x41000000, v116
    v_add_f32 v114, v114, v116
    s_nop 1
    v_add_f32_dpp v114, v114, v114 row_ror:8 row_mask:0xf bank_mask:0xf
    s_nop 1
    v_add_f32_dpp v114, v114, v114 row_ror:4 row_mask:0xf bank_mask:0xf
    s_nop 1
    v_add_f32_dpp v114, v114, v114 row_ror:2 row_mask:0xf bank_mask:0xf
    s_nop 1
    v_add_f32_dpp v114, v114, v114 row_ror:1 row_mask:0xf bank_mask:0xf
    v_mul_f32 v114, 0x3b000000, v114
    v_cvt_pk_bf16_f32 v116, v114, v113
    v_lshlrev_b32 v114, 16, v116
    v_and_b32 v113, s88, v116
    v_add_f32 v114, 0x3727c5ac, v114
    v_cvt_pk_bf16_f32 v116, v114, v115
    v_lshlrev_b32 v114, 16, v116
    v_and_b32 v115, s88, v116
    v_sqrt_f32 v114, v114
    s_nop 0
    v_cvt_pk_bf16_f32 v116, v114, v115
    v_lshlrev_b32 v114, 16, v116
    v_and_b32 v115, s88, v116
    ds_bpermute_b32 v113, v15, v113
    ds_bpermute_b32 v114, v15, v114
    s_waitcnt lgkmcnt(0)
    v_rcp_f32 v100, v114
    v_sub_f32 v128, v128, v113
    v_sub_f32 v129, v129, v113
    v_sub_f32 v130, v130, v113
    v_sub_f32 v131, v131, v113
    v_sub_f32 v132, v132, v113
    v_sub_f32 v133, v133, v113
    v_sub_f32 v134, v134, v113
    v_sub_f32 v135, v135, v113
    v_cvt_pk_bf16_f32 v101, v128, v129
    v_lshlrev_b32 v128, 16, v101
    v_and_b32 v129, s88, v101
    v_cvt_pk_bf16_f32 v102, v130, v131
    v_lshlrev_b32 v130, 16, v102
    v_and_b32 v131, s88, v102
    v_cvt_pk_bf16_f32 v101, v132, v133
    v_lshlrev_b32 v132, 16, v101
    v_and_b32 v133, s88, v101
    v_cvt_pk_bf16_f32 v102, v134, v135
    v_lshlrev_b32 v134, 16, v102
    v_and_b32 v135, s88, v102
    v_mul_f32 v128, v128, v100
    v_mul_f32 v129, v129, v100
    v_mul_f32 v130, v130, v100
    v_mul_f32 v131, v131, v100
    v_mul_f32 v132, v132, v100
    v_mul_f32 v133, v133, v100
    v_mul_f32 v134, v134, v100
    v_mul_f32 v135, v135, v100
    v_cvt_pk_bf16_f32 v101, v128, v129
    v_lshlrev_b32 v128, 16, v101
    v_and_b32 v129, s88, v101
    v_cvt_pk_bf16_f32 v102, v130, v131
    v_lshlrev_b32 v130, 16, v102
    v_and_b32 v131, s88, v102
    v_cvt_pk_bf16_f32 v101, v132, v133
    v_lshlrev_b32 v132, 16, v101
    v_and_b32 v133, s88, v101
    v_cvt_pk_bf16_f32 v102, v134, v135
    v_lshlrev_b32 v134, 16, v102
    v_and_b32 v135, s88, v102
    v_pk_mul_f32 v[128:129], v[128:129], v[24:25]
    v_pk_mul_f32 v[130:131], v[130:131], v[26:27]
    v_pk_mul_f32 v[132:133], v[132:133], v[28:29]
    v_pk_mul_f32 v[134:135], v[134:135], v[30:31]
    v_cvt_pk_bf16_f32 v104, v128, v129
    v_lshlrev_b32 v128, 16, v104
    v_and_b32 v129, s88, v104
    v_cvt_pk_bf16_f32 v105, v130, v131
    v_lshlrev_b32 v130, 16, v105
    v_and_b32 v131, s88, v105
    v_cvt_pk_bf16_f32 v104, v132, v133
    v_lshlrev_b32 v132, 16, v104
    v_and_b32 v133, s88, v104
    v_cvt_pk_bf16_f32 v105, v134, v135
    v_lshlrev_b32 v134, 16, v105
    v_and_b32 v135, s88, v105
    v_pk_add_f32 v[128:129], v[128:129], v[16:17]
    v_pk_add_f32 v[130:131], v[130:131], v[18:19]
    v_pk_add_f32 v[132:133], v[132:133], v[20:21]
    v_pk_add_f32 v[134:135], v[134:135], v[22:23]
    v_cvt_pk_bf16_f32 v96, v128, v129
    v_cvt_pk_bf16_f32 v97, v130, v131
    v_cvt_pk_bf16_f32 v98, v132, v133
    v_cvt_pk_bf16_f32 v99, v134, v135
    v_cndmask_b32 v4, v96, 0, s[64:65]
    v_cndmask_b32 v16, 0, v96, s[64:65]
    v_cndmask_b32 v5, v97, 0, s[64:65]
    v_cndmask_b32 v17, 0, v97, s[64:65]
    v_cndmask_b32 v6, v98, 0, s[64:65]
    v_cndmask_b32 v18, 0, v98, s[64:65]
    v_cndmask_b32 v7, v99, 0, s[64:65]
    v_cndmask_b32 v19, 0, v99, s[64:65]
    s_nop 0
    v_mfma_f32_16x16x32_bf16 v[96:99], v[4:7], v[32:35], 0
    v_mfma_f32_16x16x32_bf16 v[100:103], v[4:7], v[36:39], 0
    v_mfma_f32_16x16x32_bf16 v[104:107], v[4:7], v[40:43], 0
    v_mfma_f32_16x16x32_bf16 v[108:111], v[4:7], v[44:47], 0
    v_mfma_f32_16x16x32_bf16 v[112:115], v[4:7], v[48:51], 0
    v_mfma_f32_16x16x32_bf16 v[116:119], v[4:7], v[52:55], 0
    v_mfma_f32_16x16x32_bf16 v[120:123], v[4:7], v[56:59], 0
    v_mfma_f32_16x16x32_bf16 v[124:127], v[4:7], v[60:63], 0
    v_mfma_f32_16x16x32_bf16 v[96:99], v[16:19], v[64:67], v[96:99]
    v_mfma_f32_16x16x32_bf16 v[100:103], v[16:19], v[68:71], v[100:103]
    v_mfma_f32_16x16x32_bf16 v[104:107], v[16:19], v[72:75], v[104:107]
    v_mfma_f32_16x16x32_bf16 v[108:111], v[16:19], v[76:79], v[108:111]
    v_mfma_f32_16x16x32_bf16 v[112:115], v[16:19], v[80:83], v[112:115]
    v_mfma_f32_16x16x32_bf16 v[116:119], v[16:19], v[84:87], v[116:119]
    v_mfma_f32_16x16x32_bf16 v[120:123], v[16:19], v[88:91], v[120:123]
    v_mfma_f32_16x16x32_bf16 v[124:127], v[16:19], v[92:95], v[124:127]
    s_nop 0
    v_add_f32_dpp v128, v97, v96 row_ror:8 row_mask:0xf bank_mask:0xf
    v_add_f32_dpp v129, v99, v98 row_ror:8 row_mask:0xf bank_mask:0xf
    v_add_f32_dpp v130, v101, v100 row_ror:8 row_mask:0xf bank_mask:0xf
    v_add_f32_dpp v131, v103, v102 row_ror:8 row_mask:0xf bank_mask:0xf
    v_add_f32_dpp v132, v105, v104 row_ror:8 row_mask:0xf bank_mask:0xf
    v_add_f32_dpp v133, v107, v106 row_ror:8 row_mask:0xf bank_mask:0xf
    v_add_f32_dpp v134, v109, v108 row_ror:8 row_mask:0xf bank_mask:0xf
    v_add_f32_dpp v135, v111, v110 row_ror:8 row_mask:0xf bank_mask:0xf
    v_add_f32_dpp v136, v113, v112 row_ror:8 row_mask:0xf bank_mask:0xf
    v_add_f32_dpp v137, v115, v114 row_ror:8 row_mask:0xf bank_mask:0xf
    v_add_f32_dpp v138, v117, v116 row_ror:8 row_mask:0xf bank_mask:0xf
    v_add_f32_dpp v139, v119, v118 row_ror:8 row_mask:0xf bank_mask:0xf
    v_add_f32_dpp v140, v121, v120 row_ror:8 row_mask:0xf bank_mask:0xf
    v_add_f32_dpp v141, v123, v122 row_ror:8 row_mask:0xf bank_mask:0xf
    v_add_f32_dpp v142, v125, v124 row_ror:8 row_mask:0xf bank_mask:0xf
    v_add_f32_dpp v143, v127, v126 row_ror:8 row_mask:0xf bank_mask:0xf
    v_permlane32_swap_b32 v128, v129
    v_permlane32_swap_b32 v130, v131
    v_permlane32_swap_b32 v132, v133
    v_permlane32_swap_b32 v134, v135
    v_permlane32_swap_b32 v136, v137
    v_permlane32_swap_b32 v138, v139
    v_permlane32_swap_b32 v140, v141
    v_permlane32_swap_b32 v142, v143
    v_add_f32 v144, v128, v129
    v_add_f32 v145, v130, v131
    v_add_f32 v146, v132, v133
    v_add_f32 v147, v134, v135
    v_add_f32 v148, v136, v137
    v_add_f32 v149, v138, v139
    v_add_f32 v150, v140, v141
    v_add_f32 v151, v142, v143
    v_perm_b32 v16, v144, v3, s72
    v_perm_b32 v17, v145, v3, s73
    v_perm_b32 v18, v146, v3, s74
    v_perm_b32 v19, v147, v3, s75
    v_perm_b32 v20, v148, v3, s72
    v_perm_b32 v21, v149, v3, s73
    v_perm_b32 v22, v150, v3, s74
    v_perm_b32 v23, v151, v3, s75
    s_mov_b32 exec_lo, 0xff00ff
    s_mov_b32 exec_hi, 0xff00ff
    s_cmp_eq_u32 s22, 1
    s_cbranch_scc0 slow_58
    buffer_store_dwordx4 v[16:19], v14, s[4:7], s62 offen
    buffer_store_dwordx4 v[20:23], v14, s[4:7], s62 offen offset:1024
    s_branch st_done_59
slow_58:
    buffer_store_dwordx4 v[16:19], v14, s[4:7], s62 offen sc1
    buffer_store_dwordx4 v[20:23], v14, s[4:7], s62 offen offset:1024 sc1
st_done_59:
    s_mov_b64 exec, -1
    v_mov_b32 v8, 0
    v_mov_b32 v9, 1
    s_mov_b64 s[86:87], exec
    s_mov_b64 exec, 1
    ds_write_b32 v8, v9 offset:68
    s_mov_b64 exec, s[86:87]
    s_endpgm
c1end_45:
    v_mov_b32 v8, 0
spin_60:
    ds_read_b32 v9, v8 offset:64
    s_waitcnt lgkmcnt(0)
    v_readfirstlane_b32 s24, v9
    s_nop 0
    s_cmp_ge_u32 s24, 1
    s_cbranch_scc1 spun_61
    s_cmp_eq_u32 s80, 0
    s_cbranch_scc1 spun_61
    s_sub_u32 s80, s80, 1
    s_sleep 8
    s_branch spin_60
spun_61:
    v_mov_b32 v8, 0
    v_mov_b32 v9, 1
    s_mov_b64 s[86:87], exec
    s_mov_b64 exec, 1
    ds_write_b32 v8, v9 offset:68
    s_mov_b64 exec, s[86:87]
    s_endpgm
L_C2:
    s_nop 4
    v_mov_b32 v10, 0
spin_62:
    ds_read_b32 v11, v10 offset:88
    s_waitcnt lgkmcnt(0)
    v_readfirstlane_b32 s24, v11
    s_nop 0
    s_cmp_ge_u32 s24, 4
    s_cbranch_scc1 spun_63
    s_cmp_eq_u32 s80, 0
    s_cbranch_scc1 spun_63
    s_sub_u32 s80, s80, 1
    s_sleep 4
    s_branch spin_62
spun_63:
    v_bfe_u32 v10, v0, 3, 2
    v_lshrrev_b32 v11, 5, v0
    s_lshl_b32 s24, s17, 1
    v_add_u32 v11, s24, v11
    v_and_b32 v13, 15, v11
    v_bfe_u32 v14, v13, 1, 2
    v_lshlrev_b32 v8, 4, v14
    v_and_b32 v14, 8, v13
    v_add_u32 v8, v8, v14
    v_and_b32 v14, 1, v13
    v_add_u32 v8, v8, v14
    v_lshl_add_u32 v8, v10, 1, v8
    v_lshlrev_b32 v8, 4, v8
    s_mul_i32 s28, s19, 3072
    s_add_u32 s28, s28, 90112
    s_mul_i32 s29, s19, 3072
    s_add_u32 s29, s29, 163840
    s_mul_i32 s30, s19, 3072
    s_add_u32 s30, s30, 126976
    s_mul_i32 s31, s19, 3072
    s_add_u32 s31, s31, 200704
    s_mov_b32 s12, s32
    s_mov_b32 s13, s33
    s_and_b32 s13, s13, 0xffff
    s_mov_b32 s14, 4096
    s_mov_b32 s15, 0x00020000
    v_lshlrev_b32 v12, 10, v10
    v_lshlrev_b32 v13, 4, v11
    v_add_u32 v12, v12, v13
    v_and_b32 v13, 7, v0
    v_lshlrev_b32 v13, 1, v13
    v_add_u32 v12, v12, v13
    buffer_load_ushort v4, v12, s[12:15], 0 offen
poll_64:
    buffer_load_dwordx4 v[96:99], v8, s[4:7], s28 offen offset:0 sc1
    buffer_load_dwordx4 v[100:103], v8, s[4:7], s28 offen offset:1024 sc1
    buffer_load_dwordx4 v[104:107], v8, s[4:7], s28 offen offset:2048 sc1
    buffer_load_dwordx4 v[108:111], v8, s[4:7], s29 offen offset:0 sc1
    buffer_load_dwordx4 v[112:115], v8, s[4:7], s29 offen offset:1024 sc1
    buffer_load_dwordx4 v[116:119], v8, s[4:7], s29 offen offset:2048 sc1
    buffer_load_dwordx4 v[120:123], v8, s[4:7], s30 offen offset:0 sc1
    buffer_load_dwordx4 v[124:127], v8, s[4:7], s30 offen offset:1024 sc1
    buffer_load_dwordx4 v[128:131], v8, s[4:7], s30 offen offset:2048 sc1
    buffer_load_dwordx4 v[132:135], v8, s[4:7], s31 offen offset:0 sc1
    buffer_load_dwordx4 v[136:139], v8, s[4:7], s31 offen offset:1024 sc1
    buffer_load_dwordx4 v[140:143], v8, s[4:7], s31 offen offset:2048 sc1
    v_mov_b32 v9, 0
    s_waitcnt vmcnt(0)
    v_bitop3_b32 v9, v9, v99, s18 bitop3:0xf6
    v_bitop3_b32 v9, v9, v103, s18 bitop3:0xf6
    v_bitop3_b32 v9, v9, v107, s18 bitop3:0xf6
    v_bitop3_b32 v9, v9, v111, s18 bitop3:0xf6
    v_bitop3_b32 v9, v9, v115, s18 bitop3:0xf6
    v_bitop3_b32 v9, v9, v119, s18 bitop3:0xf6
    v_bitop3_b32 v9, v9, v123, s18 bitop3:0xf6
    v_bitop3_b32 v9, v9, v127, s18 bitop3:0xf6
    v_bitop3_b32 v9, v9, v131, s18 bitop3:0xf6
    v_bitop3_b32 v9, v9, v135, s18 bitop3:0xf6
    v_bitop3_b32 v9, v9, v139, s18 bitop3:0xf6
    v_bitop3_b32 v9, v9, v143, s18 bitop3:0xf6
    v_cmp_ne_u32 s[82:83], 0, v9
    s_nop 0
    s_cmp_eq_u64 s[82:83], 0
    s_cbranch_scc1 polled_65
    s_cmp_eq_u32 s80, 0
    s_cbranch_scc1 polled_65
    s_sub_u32 s80, s80, 1
    s_sleep 8
    s_branch poll_64
polled_65:
    v_pk_add_f32 v[64:65], v[96:97], v[108:109]
    v_add_f32 v66, v98, v110
    v_add_f32 v67, v100, v112
    v_add_f32 v68, v101, v113
    v_add_f32 v69, v102, v114
    v_pk_add_f32 v[70:71], v[104:105], v[116:117]
    v_pk_add_f32 v[72:73], v[120:121], v[132:133]
    v_add_f32 v74, v122, v134
    v_add_f32 v75, v124, v136
    v_add_f32 v76, v125, v137
    v_add_f32 v77, v126, v138
    v_pk_add_f32 v[78:79], v[128:129], v[140:141]
    s_mov_b32 s64, 0xaaaaaaaa
    s_mov_b32 s65, 0xaaaaaaaa
    s_mov_b32 s66, 0xcccccccc
    s_mov_b32 s67, 0xcccccccc
    s_mov_b32 s68, 0xf0f0f0f0
    s_mov_b32 s69, 0xf0f0f0f0
    v_cndmask_b32 v16, v64, v65, s[64:65]
    v_cndmask_b32 v17, v66, v67, s[64:65]
    v_cndmask_b32 v18, v68, v69, s[64:65]
    v_cndmask_b32 v19, v70, v71, s[64:65]
    v_cndmask_b32 v16, v16, v17, s[66:67]
    v_cndmask_b32 v17, v18, v19, s[66:67]
    v_cndmask_b32 v80, v16, v17, s[68:69]
    v_cndmask_b32 v16, v72, v73, s[64:65]
    v_cndmask_b32 v17, v74, v75, s[64:65]
    v_cndmask_b32 v18, v76, v77, s[64:65]
    v_cndmask_b32 v19, v78, v79, s[64:65]
    v_cndmask_b32 v16, v16, v17, s[66:67]
    v_cndmask_b32 v17, v18, v19, s[66:67]
    v_cndmask_b32 v81, v16, v17, s[68:69]
    v_cvt_pk_bf16_f32 v16, v80, v81
    v_lshlrev_b32 v80, 16, v16
    v_and_b32 v81, s88, v16
    v_lshlrev_b32 v82, 16, v4
    v_and_b32 v8, 7, v0
    v_lshlrev_b32 v8, 10, v8
    v_lshrrev_b32 v14, 3, v0
    v_lshlrev_b32 v14, 4, v14
    v_add_u32 v8, v8, v14
    s_lshl_b32 s28, s17, 13
    s_add_u32 s30, s28, 2031616
    s_mul_i32 s28, s17, 12288
    s_add_u32 s28, s28, 1376256
    v_and_b32 v85, 7, v0
    v_mul_u32_u24 v85, 1536, v85
    v_add_u32 v85, v85, v14
    v_and_b32 v13, 3, v11
    v_lshlrev_b32 v13, 1, v13
    v_bfe_u32 v14, v0, 2, 1
    v_add_u32 v13, v13, v14
    v_lshlrev_b32 v13, 10, v13
    v_lshrrev_b32 v14, 2, v11
    v_lshl_add_u32 v14, v10, 4, v14
    v_lshlrev_b32 v14, 4, v14
    v_add_u32 v13, v13, v14
    v_and_b32 v15, 3, v11
    v_lshlrev_b32 v15, 10, v15
    v_add_u32 v15, v15, v14
    s_lshl_b32 s61, s16, 13
    s_add_u32 s61, s61, 475136
    s_lshl_b32 s62, s16, 12
    s_add_u32 s62, s62, 540672
    v_and_b32 v83, 3, v0
    v_or_b32 v83, 0x07060500, v83
    v_mov_b32 v22, v3
    v_mov_b32 v23, v3
    s_mov_b32 s12, s54
    s_mov_b32 s13, s55
    s_and_b32 s13, s13, 0xffff
    s_mov_b32 s14, 4096
    s_mov_b32 s15, 0x00020000
    buffer_load_ushort v84, v12, s[12:15], 0 offen
    v_mov_b32 v1, 0
spin_66:
    ds_read_b32 v2, v1 offset:44
    s_waitcnt lgkmcnt(0)
    v_readfirstlane_b32 s24, v2
    s_nop 0
    s_cmp_ge_u32 s24, 1
    s_cbranch_scc1 spun_67
    s_cmp_eq_u32 s80, 0
    s_cbranch_scc1 spun_67
    s_sub_u32 s80, s80, 1
    s_sleep 1
    s_branch spin_66
spun_67:
    s_mov_b32 s22, s24
    v_mov_b32 v16, 0
spin_68:
    ds_read_b32 v17, v16 offset:60
    s_waitcnt lgkmcnt(0)
    v_readfirstlane_b32 s24, v17
    s_nop 0
    s_cmp_ge_u32 s24, 1
    s_cbranch_scc1 spun_69
    s_cmp_eq_u32 s80, 0
    s_cbranch_scc1 spun_69
    s_sub_u32 s80, s80, 1
    s_branch spin_68
spun_69:
poll_70:
    buffer_load_dwordx4 v[32:35], v85, s[4:7], s28 offen offset:0 sc1
    buffer_load_dwordx4 v[36:39], v85, s[4:7], s28 offen offset:128 sc1
    buffer_load_dwordx4 v[40:43], v85, s[4:7], s28 offen offset:256 sc1
    buffer_load_dwordx4 v[44:47], v85, s[4:7], s28 offen offset:384 sc1
    buffer_load_dwordx4 v[48:51], v85, s[4:7], s28 offen offset:512 sc1
    buffer_load_dwordx4 v[52:55], v85, s[4:7], s28 offen offset:640 sc1
    buffer_load_dwordx4 v[56:59], v85, s[4:7], s28 offen offset:768 sc1
    buffer_load_dwordx4 v[60:63], v85, s[4:7], s28 offen offset:896 sc1
    buffer_load_dwordx4 v[64:67], v85, s[4:7], s28 offen offset:1024 sc1
    buffer_load_dwordx4 v[68:71], v85, s[4:7], s28 offen offset:1152 sc1
    buffer_load_dwordx4 v[72:75], v85, s[4:7], s28 offen offset:1280 sc1
    buffer_load_dwordx4 v[76:79], v85, s[4:7], s28 offen offset:1408 sc1
    v_mov_b32 v9, 0
    s_waitcnt vmcnt(6)
    v_bitop3_b32 v9, v9, v35, s18 bitop3:0xf6
    v_bitop3_b32 v9, v9, v39, s18 bitop3:0xf6
    v_bitop3_b32 v9, v9, v43, s18 bitop3:0xf6
    v_bitop3_b32 v9, v9, v47, s18 bitop3:0xf6
    v_bitop3_b32 v9, v9, v51, s18 bitop3:0xf6
    v_bitop3_b32 v9, v9, v55, s18 bitop3:0xf6
    v_pk_add_f32 v[96:97], v[32:33], v[44:45]
    v_add_f32 v98, v34, v46
    v_add_f32 v99, v36, v48
    v_add_f32 v100, v37, v49
    v_add_f32 v101, v38, v50
    v_pk_add_f32 v[102:103], v[40:41], v[52:53]
    s_waitcnt vmcnt(0)
    v_bitop3_b32 v9, v9, v59, s18 bitop3:0xf6
    v_bitop3_b32 v9, v9, v63, s18 bitop3:0xf6
    v_bitop3_b32 v9, v9, v67, s18 bitop3:0xf6
    v_bitop3_b32 v9, v9, v71, s18 bitop3:0xf6
    v_bitop3_b32 v9, v9, v75, s18 bitop3:0xf6
    v_bitop3_b32 v9, v9, v79, s18 bitop3:0xf6
    v_pk_add_f32 v[104:105], v[56:57], v[68:69]
    v_add_f32 v106, v58, v70
    v_add_f32 v107, v60, v72
    v_add_f32 v108, v61, v73
    v_add_f32 v109, v62, v74
    v_pk_add_f32 v[110:111], v[64:65], v[76:77]
    v_cmp_ne_u32 s[82:83], 0, v9
    s_nop 0
    s_cmp_eq_u64 s[82:83], 0
    s_cbranch_scc1 polled_71
    s_cmp_eq_u32 s80, 0
    s_cbranch_scc1 polled_71
    s_sub_u32 s80, s80, 1
    s_branch poll_70
polled_71:
    v_pk_add_f32 v[32:33], v[96:97], v[104:105]
    v_pk_add_f32 v[34:35], v[98:99], v[106:107]
    v_pk_add_f32 v[36:37], v[100:101], v[108:109]
    v_pk_add_f32 v[38:39], v[102:103], v[110:111]
    v_cndmask_b32 v40, v32, v36, s[68:69]
    v_cndmask_b32 v44, v36, v32, s[68:69]
    v_cndmask_b32 v41, v33, v37, s[68:69]
    v_cndmask_b32 v45, v37, v33, s[68:69]
    v_cndmask_b32 v42, v34, v38, s[68:69]
    v_cndmask_b32 v46, v38, v34, s[68:69]
    v_cndmask_b32 v43, v35, v39, s[68:69]
    v_cndmask_b32 v47, v39, v35, s[68:69]
    v_add_f32_dpp v40, v44, v40 row_half_mirror row_mask:0xf bank_mask:0xf
    v_add_f32_dpp v41, v45, v41 row_half_mirror row_mask:0xf bank_mask:0xf
    v_add_f32_dpp v42, v46, v42 row_half_mirror row_mask:0xf bank_mask:0xf
    v_add_f32_dpp v43, v47, v43 row_half_mirror row_mask:0xf bank_mask:0xf
    v_cndmask_b32 v48, v40, v41, s[64:65]
    v_cndmask_b32 v50, v41, v40, s[64:65]
    v_cndmask_b32 v49, v42, v43, s[64:65]
    v_cndmask_b32 v51, v43, v42, s[64:65]
    v_add_f32_dpp v48, v50, v48 quad_perm:[1,0,3,2] row_mask:0xf bank_mask:0xf
    s_nop 0
    v_add_f32_dpp v49, v51, v49 quad_perm:[1,0,3,2] row_mask:0xf bank_mask:0xf
    v_cndmask_b32 v52, v48, v49, s[66:67]
    v_cndmask_b32 v53, v49, v48, s[66:67]
    s_nop 1
    v_add_f32_dpp v16, v53, v52 quad_perm:[2,3,0,1] row_mask:0xf bank_mask:0xf
    v_cvt_pk_bf16_f32 v17, v16, v16
    v_lshlrev_b32 v16, 16, v17
    v_mul_f32 v16, v16, v80
    v_cvt_pk_bf16_f32 v17, v16, v16
    v_lshlrev_b32 v16, 16, v17
    v_add_f32 v82, v82, v16
    v_cvt_pk_bf16_f32 v17, v82, v82
    v_lshlrev_b32 v82, 16, v17
    v_perm_b32 v17, v82, v3, v83
    s_nop 0
    v_add_f32_dpp v20, v82, v82 quad_perm:[1,0,3,2] row_mask:0xf bank_mask:0xf
    v_mov_b32_dpp v24, v17 quad_perm:[0,0,0,0] row_mask:0xf bank_mask:0xf
    v_mov_b32_dpp v25, v17 quad_perm:[1,1,1,1] row_mask:0xf bank_mask:0xf
    v_mov_b32_dpp v26, v17 quad_perm:[2,2,2,2] row_mask:0xf bank_mask:0xf
    v_mov_b32_dpp v27, v17 quad_perm:[3,3,3,3] row_mask:0xf bank_mask:0xf
    v_add_f32_dpp v20, v20, v20 quad_perm:[2,3,0,1] row_mask:0xf bank_mask:0xf
    s_mov_b32 exec_lo, 0x11111111
    s_mov_b32 exec_hi, 0x11111111
    s_cmp_eq_u32 s22, 1
    s_cbranch_scc0 slow_72
    buffer_store_dwordx4 v[24:27], v13, s[4:7], s61 offen
    s_branch st_done_73
slow_72:
    buffer_store_dwordx4 v[24:27], v13, s[4:7], s61 offen sc1
st_done_73:
    s_mov_b64 exec, -1
    v_add_f32_dpp v20, v20, v20 row_half_mirror row_mask:0xf bank_mask:0xf
    v_mul_f32 v18, 0x3e000000, v20
    v_sub_f32 v21, v82, v18
    v_mul_f32 v21, v21, v21
    s_nop 1
    v_add_f32_dpp v21, v21, v21 quad_perm:[1,0,3,2] row_mask:0xf bank_mask:0xf
    s_nop 1
    v_add_f32_dpp v21, v21, v21 quad_perm:[2,3,0,1] row_mask:0xf bank_mask:0xf
    s_nop 1
    v_add_f32_dpp v21, v21, v21 row_half_mirror row_mask:0xf bank_mask:0xf
    s_mov_b32 exec_lo, 0x1010101
    s_mov_b32 exec_hi, 0x1010101
    s_cmp_eq_u32 s22, 1
    s_cbranch_scc0 slow_74
    buffer_store_dwordx4 v[20:23], v15, s[4:7], s62 offen
    s_branch st_done_75
slow_74:
    buffer_store_dwordx4 v[20:23], v15, s[4:7], s62 offen sc1
st_done_75:
    s_mov_b64 exec, -1
    v_mov_b32 v24, 0
    v_mov_b32 v25, 1
    s_mov_b64 s[86:87], exec
    s_mov_b64 exec, 1
    ds_write_b32 v24, v25 offset:64
    s_mov_b64 exec, s[86:87]
    s_cmp_eq_u32 s16, s20
    s_cbranch_scc0 c2end_76
    v_mov_b32 v56, s76
    v_mov_b32 v57, s77
    v_mov_b32 v58, s78
    v_mov_b32 v59, s79
    v_mov_b32 v60, s76
    v_mov_b32 v61, s77
    v_mov_b32 v62, s78
    v_mov_b32 v63, s79
    v_and_b32 v56, 0xff, v56
    v_and_b32 v57, 0xff, v57
    v_and_b32 v58, 0xff, v58
    v_and_b32 v59, 0xff, v59
    v_and_b32 v60, 0xff, v60
    v_and_b32 v61, 0xff, v61
    v_and_b32 v62, 0xff, v62
    v_and_b32 v63, 0xff, v63
    v_mov_b32 v16, 0
spin_77:
    ds_read_b32 v17, v16 offset:72
    s_waitcnt lgkmcnt(0)
    v_readfirstlane_b32 s24, v17
    s_nop 0
    s_cmp_ge_u32 s24, 1
    s_cbranch_scc1 spun_78
    s_cmp_eq_u32 s80, 0
    s_cbranch_scc1 spun_78
    s_sub_u32 s80, s80, 1
    s_branch spin_77
spun_78:
poll_79:
    buffer_load_dwordx4 v[32:35], v8, s[4:7], s30 offen offset:0 sc1
    buffer_load_dwordx4 v[36:39], v8, s[4:7], s30 offen offset:128 sc1
    buffer_load_dwordx4 v[40:43], v8, s[4:7], s30 offen offset:256 sc1
    buffer_load_dwordx4 v[44:47], v8, s[4:7], s30 offen offset:384 sc1
    buffer_load_dwordx4 v[48:51], v8, s[4:7], s30 offen offset:512 sc1
    buffer_load_dwordx4 v[52:55], v8, s[4:7], s30 offen offset:640 sc1
    s_mov_b32 exec_lo, 0xf0f0f0f
    s_mov_b32 exec_hi, 0xf0f0f0f
    buffer_load_dwordx4 v[56:59], v8, s[4:7], s30 offen offset:768 sc1
    buffer_load_dwordx4 v[60:63], v8, s[4:7], s30 offen offset:896 sc1
    s_mov_b64 exec, -1
    v_mov_b32 v9, 0
    s_waitcnt vmcnt(4)
    v_bitop3_b32 v9, v9, v32, s76 bitop3:0xf6
    v_bitop3_b32 v9, v9, v33, s77 bitop3:0xf6
    v_bitop3_b32 v9, v9, v34, s78 bitop3:0xf6
    v_bitop3_b32 v9, v9, v35, s79 bitop3:0xf6
    v_bitop3_b32 v9, v9, v36, s76 bitop3:0xf6
    v_bitop3_b32 v9, v9, v37, s77 bitop3:0xf6
    v_bitop3_b32 v9, v9, v38, s78 bitop3:0xf6
    v_bitop3_b32 v9, v9, v39, s79 bitop3:0xf6
    v_bitop3_b32 v9, v9, v40, s76 bitop3:0xf6
    v_bitop3_b32 v9, v9, v41, s77 bitop3:0xf6
    v_bitop3_b32 v9, v9, v42, s78 bitop3:0xf6
    v_bitop3_b32 v9, v9, v43, s79 bitop3:0xf6
    v_bitop3_b32 v9, v9, v44, s76 bitop3:0xf6
    v_bitop3_b32 v9, v9, v45, s77 bitop3:0xf6
    v_bitop3_b32 v9, v9, v46, s78 bitop3:0xf6
    v_bitop3_b32 v9, v9, v47, s79 bitop3:0xf6
    v_pk_add_f32 v[32:33], v[32:33], v[40:41]
    v_pk_add_f32 v[34:35], v[34:35], v[42:43]
    v_pk_add_f32 v[36:37], v[36:37], v[44:45]
    v_pk_add_f32 v[38:39], v[38:39], v[46:47]
    s_waitcnt vmcnt(0)
    v_bitop3_b32 v9, v9, v48, s76 bitop3:0xf6
    v_bitop3_b32 v9, v9, v49, s77 bitop3:0xf6
    v_bitop3_b32 v9, v9, v50, s78 bitop3:0xf6
    v_bitop3_b32 v9, v9, v51, s79 bitop3:0xf6
    v_bitop3_b32 v9, v9, v52, s76 bitop3:0xf6
    v_bitop3_b32 v9, v9, v53, s77 bitop3:0xf6
    v_bitop3_b32 v9, v9, v54, s78 bitop3:0xf6
    v_bitop3_b32 v9, v9, v55, s79 bitop3:0xf6
    v_bitop3_b32 v9, v9, v56, s76 bitop3:0xf6
    v_bitop3_b32 v9, v9, v57, s77 bitop3:0xf6
    v_bitop3_b32 v9, v9, v58, s78 bitop3:0xf6
    v_bitop3_b32 v9, v9, v59, s79 bitop3:0xf6
    v_bitop3_b32 v9, v9, v60, s76 bitop3:0xf6
    v_bitop3_b32 v9, v9, v61, s77 bitop3:0xf6
    v_bitop3_b32 v9, v9, v62, s78 bitop3:0xf6
    v_bitop3_b32 v9, v9, v63, s79 bitop3:0xf6
    v_pk_add_f32 v[48:49], v[48:49], v[56:57]
    v_pk_add_f32 v[50:51], v[50:51], v[58:59]
    v_pk_add_f32 v[52:53], v[52:53], v[60:61]
    v_pk_add_f32 v[54:55], v[54:55], v[62:63]
    v_and_b32 v9, 0xff, v9
    v_cmp_ne_u32 s[82:83], 0, v9
    s_nop 0
    s_cmp_eq_u64 s[82:83], 0
    s_cbranch_scc1 polled_80
    s_cmp_eq_u32 s80, 0
    s_cbranch_scc1 polled_80
    s_sub_u32 s80, s80, 1
    s_branch poll_79
polled_80:
    v_pk_add_f32 v[32:33], v[32:33], v[48:49]
    v_pk_add_f32 v[34:35], v[34:35], v[50:51]
    v_pk_add_f32 v[36:37], v[36:37], v[52:53]
    v_pk_add_f32 v[38:39], v[38:39], v[54:55]
    v_cndmask_b32 v40, v32, v36, s[68:69]
    v_cndmask_b32 v44, v36, v32, s[68:69]
    v_cndmask_b32 v41, v33, v37, s[68:69]
    v_cndmask_b32 v45, v37, v33, s[68:69]
    v_cndmask_b32 v42, v34, v38, s[68:69]
    v_cndmask_b32 v46, v38, v34, s[68:69]
    v_cndmask_b32 v43, v35, v39, s[68:69]
    v_cndmask_b32 v47, v39, v35, s[68:69]
    v_add_f32_dpp v40, v44, v40 row_half_mirror row_mask:0xf bank_mask:0xf
    v_add_f32_dpp v41, v45, v41 row_half_mirror row_mask:0xf bank_mask:0xf
    v_add_f32_dpp v42, v46, v42 row_half_mirror row_mask:0xf bank_mask:0xf
    v_add_f32_dpp v43, v47, v43 row_half_mirror row_mask:0xf bank_mask:0xf
    v_cndmask_b32 v48, v40, v41, s[64:65]
    v_cndmask_b32 v50, v41, v40, s[64:65]
    v_cndmask_b32 v49, v42, v43, s[64:65]
    v_cndmask_b32 v51, v43, v42, s[64:65]
    v_add_f32_dpp v48, v50, v48 quad_perm:[1,0,3,2] row_mask:0xf bank_mask:0xf
    s_nop 0
    v_add_f32_dpp v49, v51, v49 quad_perm:[1,0,3,2] row_mask:0xf bank_mask:0xf
    v_cndmask_b32 v52, v48, v49, s[66:67]
    v_cndmask_b32 v53, v49, v48, s[66:67]
    s_nop 1
    v_add_f32_dpp v16, v53, v52 quad_perm:[2,3,0,1] row_mask:0xf bank_mask:0xf
    v_cvt_pk_bf16_f32 v17, v16, v16
    v_lshlrev_b32 v16, 16, v17
    v_mul_f32 v16, v16, v81
    v_cvt_pk_bf16_f32 v17, v16, v16
    v_lshlrev_b32 v16, 16, v17
    v_add_f32 v16, v82, v16
    v_cvt_pk_bf16_f32 v16, v16, v16
    buffer_store_short v16, v12, s[12:15], 0 offen
    s_cmp_eq_u32 s2, 0
    s_cbranch_scc0 c2end_76
    s_mov_b64 exec, 1
    v_mov_b32 v9, 0
    buffer_store_dword v3, v9, s[4:7], 0 offen
c2end_76:
    s_endpgm
L_K2:
    s_nop 4
    s_mov_b32 s70, 0x05040100
    s_mov_b32 s71, 0x07060302
    s_mov_b32 s72, 0x7060500
    s_mov_b32 s73, 0x7060501
    s_mov_b32 s74, 0x7060502
    s_mov_b32 s75, 0x7060503
    s_mov_b32 s88, 0xffff0000
    s_mov_b32 s89, 0x3fb8aa3b
    s_mov_b32 s80, 0x20000
    s_mov_b32 s4, s58
    s_mov_b32 s5, s59
    s_and_b32 s5, s5, 0xffff
    s_mov_b32 s6, 268435456
    s_mov_b32 s7, 0x00020000
    s_load_dword s60, s[58:59], 0
    s_waitcnt lgkmcnt(0)
    s_add_u32 s18, s60, 0x9E3779B9
    s_mov_b32 s76, s18
    s_lshr_b32 s77, s18, 8
    s_lshr_b32 s78, s18, 16
    s_lshr_b32 s79, s18, 24
    s_mov_b32 s64, 0x22222222
    s_mov_b32 s65, 0x22222222
    s_mov_b32 s66, 0x44444444
    s_mov_b32 s67, 0x44444444
    s_mov_b32 s68, 0x88888888
    s_mov_b32 s69, 0x88888888
    s_mov_b32 s28, 0xaaaaaaaa
    s_mov_b32 s29, 0xaaaaaaaa
    s_mov_b32 s30, 0xcccccccc
    s_mov_b32 s31, 0xcccccccc
    s_lshl_b32 s24, s16, 2
    s_add_u32 s24, s24, s19
    s_lshl_b32 s24, s24, 11
    s_add_u32 s61, s24, 344064
    s_lshl_b32 s25, s20, 2
    s_add_u32 s25, s25, s21
    s_lshl_b32 s25, s25, 4
    s_add_u32 s62, s25, s61
    v_lshrrev_b32 v40, 4, v0
    v_lshlrev_b32 v40, 9, v40
    v_and_b32 v41, 15, v0
    v_lshlrev_b32 v41, 4, v41
    v_add_u32 v41, v41, v40
    v_and_b32 v2, 3, v0
    v_lshlrev_b32 v2, 1, v2
    v_add_u32 v42, v40, v2
    v_bfe_u32 v2, v0, 2, 2
    v_lshlrev_b32 v2, 4, v2
    v_add_u32 v42, v42, v2
    s_lshl_b32 s24, s21, 7
    v_add_u32 v42, s24, v42
    v_mov_b32 v14, s18
    v_mov_b32 v15, s18
    v_lshlrev_b32 v43, 4, v0
    s_lshl_b32 s24, s16, 2
    s_add_u32 s24, s24, s19
    s_lshl_b32 s24, s24, 11
    s_add_u32 s63, s24, 212992
    s_mov_b32 s26, 48
ab_81:
    buffer_load_dwordx4 v[4:7], v43, s[4:7], s63 offen sc1
    buffer_load_dwordx4 v[36:39], v43, s[4:7], s63 offen offset:1024 sc1
    v_mov_b32 v9, 0
    s_waitcnt vmcnt(0)
    v_bitop3_b32 v9, v9, v7, s18 bitop3:0xf6
    v_bitop3_b32 v9, v9, v39, s18 bitop3:0xf6
    v_cmp_ne_u32 s[82:83], 0, v9
    s_nop 0
    s_cmp_eq_u64 s[82:83], 0
    s_cbranch_scc1 abd_82
    s_cmp_eq_u32 s80, 0
    s_cbranch_scc1 abd_82
    s_sub_u32 s80, s80, 1
    s_sub_u32 s26, s26, 1
    s_cmp_eq_u32 s26, 0
    s_cbranch_scc0 abn_83
    s_add_u32 s63, s63, 65536
abn_83:
    s_sleep 1
    s_branch ab_81
abd_82:
    v_mov_b32 v7, v36
    s_nop 1
    v_mfma_f32_16x16x32_bf16 v[128:131], v[4:7], v[64:67], 0
    v_mfma_f32_16x16x32_bf16 v[132:135], v[4:7], v[68:71], 0
    v_mfma_f32_16x16x32_bf16 v[136:139], v[4:7], v[72:75], 0
    v_mfma_f32_16x16x32_bf16 v[140:143], v[4:7], v[76:79], 0
    v_mfma_f32_16x16x32_bf16 v[144:147], v[4:7], v[80:83], 0
    v_mfma_f32_16x16x32_bf16 v[148:151], v[4:7], v[84:87], 0
    v_mfma_f32_16x16x32_bf16 v[152:155], v[4:7], v[88:91], 0
    v_mfma_f32_16x16x32_bf16 v[156:159], v[4:7], v[92:95], 0
    s_nop 0
    v_cndmask_b32 v16, v128, v129, s[64:65]
    v_cndmask_b32 v17, v132, v133, s[64:65]
    v_cndmask_b32 v18, v136, v137, s[64:65]
    v_cndmask_b32 v19, v140, v141, s[64:65]
    v_cndmask_b32 v16, v16, v130, s[66:67]
    v_cndmask_b32 v17, v17, v134, s[66:67]
    v_cndmask_b32 v18, v18, v138, s[66:67]
    v_cndmask_b32 v19, v19, v142, s[66:67]
    v_cndmask_b32 v16, v16, v131, s[68:69]
    v_cndmask_b32 v17, v17, v135, s[68:69]
    v_cndmask_b32 v18, v18, v139, s[68:69]
    v_cndmask_b32 v19, v19, v143, s[68:69]
    v_cndmask_b32 v20, v16, v17, s[28:29]
    v_cndmask_b32 v21, v17, v16, s[28:29]
    v_cndmask_b32 v22, v18, v19, s[28:29]
    v_cndmask_b32 v23, v19, v18, s[28:29]
    v_add_f32_dpp v24, v21, v20 quad_perm:[1,0,3,2] row_mask:0xf bank_mask:0xf
    s_nop 0
    v_add_f32_dpp v25, v23, v22 quad_perm:[1,0,3,2] row_mask:0xf bank_mask:0xf
    v_cndmask_b32 v26, v24, v25, s[30:31]
    v_cndmask_b32 v27, v25, v24, s[30:31]
    s_nop 1
    v_add_f32_dpp v8, v27, v26 quad_perm:[2,3,0,1] row_mask:0xf bank_mask:0xf
    v_mfma_f32_16x16x32_bf16 v[128:131], v[4:7], v[96:99], 0
    v_mfma_f32_16x16x32_bf16 v[132:135], v[4:7], v[100:103], 0
    v_mfma_f32_16x16x32_bf16 v[136:139], v[4:7], v[104:107], 0
    v_mfma_f32_16x16x32_bf16 v[140:143], v[4:7], v[108:111], 0
    v_cndmask_b32 v16, v144, v145, s[64:65]
    v_cndmask_b32 v17, v148, v149, s[64:65]
    v_cndmask_b32 v18, v152, v153, s[64:65]
    v_cndmask_b32 v19, v156, v157, s[64:65]
    v_cndmask_b32 v16, v16, v146, s[66:67]
    v_cndmask_b32 v17, v17, v150, s[66:67]
    v_cndmask_b32 v18, v18, v154, s[66:67]
    v_cndmask_b32 v19, v19, v158, s[66:67]
    v_cndmask_b32 v16, v16, v147, s[68:69]
    v_cndmask_b32 v17, v17, v151, s[68:69]
    v_cndmask_b32 v18, v18, v155, s[68:69]
    v_cndmask_b32 v19, v19, v159, s[68:69]
    v_cndmask_b32 v20, v16, v17, s[28:29]
    v_cndmask_b32 v21, v17, v16, s[28:29]
    v_cndmask_b32 v22, v18, v19, s[28:29]
    v_cndmask_b32 v23, v19, v18, s[28:29]
    v_add_f32_dpp v24, v21, v20 quad_perm:[1,0,3,2] row_mask:0xf bank_mask:0xf
    s_nop 0
    v_add_f32_dpp v25, v23, v22 quad_perm:[1,0,3,2] row_mask:0xf bank_mask:0xf
    v_cndmask_b32 v26, v24, v25, s[30:31]
    v_cndmask_b32 v27, v25, v24, s[30:31]
    s_nop 1
    v_add_f32_dpp v9, v27, v26 quad_perm:[2,3,0,1] row_mask:0xf bank_mask:0xf
    v_mfma_f32_16x16x32_bf16 v[144:147], v[4:7], v[112:115], 0
    v_mfma_f32_16x16x32_bf16 v[148:151], v[4:7], v[116:119], 0
    v_mfma_f32_16x16x32_bf16 v[152:155], v[4:7], v[120:123], 0
    v_mfma_f32_16x16x32_bf16 v[156:159], v[4:7], v[124:127], 0
    v_cndmask_b32 v16, v128, v129, s[64:65]
    v_cndmask_b32 v17, v132, v133, s[64:65]
    v_cndmask_b32 v18, v136, v137, s[64:65]
    v_cndmask_b32 v19, v140, v141, s[64:65]
    v_cndmask_b32 v16, v16, v130, s[66:67]
    v_cndmask_b32 v17, v17, v134, s[66:67]
    v_cndmask_b32 v18, v18, v138, s[66:67]
    v_cndmask_b32 v19, v19, v142, s[66:67]
    v_cndmask_b32 v16, v16, v131, s[68:69]
    v_cndmask_b32 v17, v17, v135, s[68:69]
    v_cndmask_b32 v18, v18, v139, s[68:69]
    v_cndmask_b32 v19, v19, v143, s[68:69]
    v_cndmask_b32 v20, v16, v17, s[28:29]
    v_cndmask_b32 v21, v17, v16, s[28:29]
    v_cndmask_b32 v22, v18, v19, s[28:29]
    v_cndmask_b32 v23, v19, v18, s[28:29]
    v_add_f32_dpp v24, v21, v20 quad_perm:[1,0,3,2] row_mask:0xf bank_mask:0xf
    s_nop 0
    v_add_f32_dpp v25, v23, v22 quad_perm:[1,0,3,2] row_mask:0xf bank_mask:0xf
    v_cndmask_b32 v26, v24, v25, s[30:31]
    v_cndmask_b32 v27, v25, v24, s[30:31]
    s_nop 1
    v_add_f32_dpp v10, v27, v26 quad_perm:[2,3,0,1] row_mask:0xf bank_mask:0xf
    v_cndmask_b32 v16, v144, v145, s[64:65]
    v_cndmask_b32 v17, v148, v149, s[64:65]
    v_cndmask_b32 v18, v152, v153, s[64:65]
    v_cndmask_b32 v19, v156, v157, s[64:65]
    v_cndmask_b32 v16, v16, v146, s[66:67]
    v_cndmask_b32 v17, v17, v150, s[66:67]
    v_cndmask_b32 v18, v18, v154, s[66:67]
    v_cndmask_b32 v19, v19, v158, s[66:67]
    v_cndmask_b32 v16, v16, v147, s[68:69]
    v_cndmask_b32 v17, v17, v151, s[68:69]
    v_cndmask_b32 v18, v18, v155, s[68:69]
    v_cndmask_b32 v19, v19, v159, s[68:69]
    v_cndmask_b32 v20, v16, v17, s[28:29]
    v_cndmask_b32 v21, v17, v16, s[28:29]
    v_cndmask_b32 v22, v18, v19, s[28:29]
    v_cndmask_b32 v23, v19, v18, s[28:29]
    v_add_f32_dpp v24, v21, v20 quad_perm:[1,0,3,2] row_mask:0xf bank_mask:0xf
    s_nop 0
    v_add_f32_dpp v25, v23, v22 quad_perm:[1,0,3,2] row_mask:0xf bank_mask:0xf
    v_cndmask_b32 v26, v24, v25, s[30:31]
    v_cndmask_b32 v27, v25, v24, s[30:31]
    s_nop 1
    v_add_f32_dpp v11, v27, v26 quad_perm:[2,3,0,1] row_mask:0xf bank_mask:0xf
    v_cvt_pk_bf16_f32 v16, v8, v9
    v_lshlrev_b32 v8, 16, v16
    v_and_b32 v9, s88, v16
    v_cvt_pk_bf16_f32 v17, v10, v11
    v_lshlrev_b32 v10, 16, v17
    v_and_b32 v11, s88, v17
    v_mul_f32 v8, 0x3db504f3, v8
    v_mul_f32 v9, 0x3db504f3, v9
    v_mul_f32 v10, 0x3db504f3, v10
    v_mul_f32 v11, 0x3db504f3, v11
    v_cvt_pk_bf16_f32 v16, v8, v9
    v_lshlrev_b32 v8, 16, v16
    v_and_b32 v9, s88, v16
    v_cvt_pk_bf16_f32 v17, v10, v11
    v_lshlrev_b32 v10, 16, v17
    v_and_b32 v11, s88, v17
    v_max3_f32 v12, v8, v9, v10
    v_max_f32 v12, v12, v11
    s_nop 1
    v_max_f32_dpp v12, v12, v12 row_ror:8 row_mask:0xf bank_mask:0xf
    s_nop 1
    v_max_f32_dpp v12, v12, v12 row_ror:4 row_mask:0xf bank_mask:0xf
    s_nop 1
    v_max_f32_dpp v12, v12, v12 row_ror:2 row_mask:0xf bank_mask:0xf
    s_nop 1
    v_max_f32_dpp v12, v12, v12 row_ror:1 row_mask:0xf bank_mask:0xf
    v_sub_f32 v16, v8, v12
    v_sub_f32 v17, v9, v12
    v_sub_f32 v18, v10, v12
    v_sub_f32 v19, v11, v12
    v_mul_f32 v16, s89, v16
    v_mul_f32 v17, s89, v17
    v_mul_f32 v18, s89, v18
    v_mul_f32 v19, s89, v19
    v_exp_f32 v16, v16
    v_exp_f32 v17, v17
    v_exp_f32 v18, v18
    v_exp_f32 v19, v19
    v_add_f32 v13, v16, v17
    v_add_f32 v18, v18, v19
    v_add_f32 v13, v13, v18
    s_nop 1
    v_add_f32_dpp v13, v13, v13 row_ror:8 row_mask:0xf bank_mask:0xf
    s_nop 1
    v_add_f32_dpp v13, v13, v13 row_ror:4 row_mask:0xf bank_mask:0xf
    s_nop 1
    v_add_f32_dpp v13, v13, v13 row_ror:2 row_mask:0xf bank_mask:0xf
    s_nop 1
    v_add_f32_dpp v13, v13, v13 row_ror:1 row_mask:0xf bank_mask:0xf
    s_mov_b32 exec_lo, 0x00010001
    s_mov_b32 exec_hi, 0x00010001
    buffer_store_dwordx4 v[12:15], v40, s[4:7], s62 offen
    s_add_u32 s62, s62, 65536
    buffer_store_dwordx4 v[12:15], v40, s[4:7], s62 offen sc1
    s_mov_b64 exec, -1
    s_mov_b32 s26, 48
ab_84:
    buffer_load_dwordx4 v[16:19], v41, s[4:7], s61 offen sc1
    buffer_load_dwordx4 v[20:23], v41, s[4:7], s61 offen offset:256 sc1
    v_mov_b32 v2, 0
    s_waitcnt vmcnt(0)
    v_bitop3_b32 v2, v2, v19, s18 bitop3:0xf6
    v_bitop3_b32 v2, v2, v23, s18 bitop3:0xf6
    v_cmp_ne_u32 s[82:83], 0, v2
    s_nop 0
    s_cmp_eq_u64 s[82:83], 0
    s_cbranch_scc1 abd_85
    s_cmp_eq_u32 s80, 0
    s_cbranch_scc1 abd_85
    s_sub_u32 s80, s80, 1
    s_sub_u32 s26, s26, 1
    s_cmp_eq_u32 s26, 0
    s_cbranch_scc0 abn_86
    s_add_u32 s61, s61, 65536
abn_86:
    s_branch ab_84
abd_85:
    v_max_f32 v12, v16, v20
    s_nop 1
    v_max_f32_dpp v12, v12, v12 row_ror:8 row_mask:0xf bank_mask:0xf
    s_nop 1
    v_max_f32_dpp v12, v12, v12 row_ror:4 row_mask:0xf bank_mask:0xf
    s_nop 1
    v_max_f32_dpp v12, v12, v12 row_ror:2 row_mask:0xf bank_mask:0xf
    s_nop 1
    v_max_f32_dpp v12, v12, v12 row_ror:1 row_mask:0xf bank_mask:0xf
    v_sub_f32 v16, v16, v12
    v_sub_f32 v20, v20, v12
    v_sub_f32 v24, v8, v12
    v_sub_f32 v25, v9, v12
    v_sub_f32 v26, v10, v12
    v_sub_f32 v27, v11, v12
    v_mul_f32 v16, s89, v16
    v_mul_f32 v20, s89, v20
    v_mul_f32 v24, s89, v24
    v_mul_f32 v25, s89, v25
    v_mul_f32 v26, s89, v26
    v_mul_f32 v27, s89, v27
    v_exp_f32 v16, v16
    v_exp_f32 v20, v20
    v_exp_f32 v24, v24
    v_exp_f32 v25, v25
    v_exp_f32 v26, v26
    v_exp_f32 v27, v27
    v_mul_f32 v16, v16, v17
    v_fma_f32 v13, v20, v21, v16
    s_nop 1
    v_add_f32_dpp v13, v13, v13 row_ror:8 row_mask:0xf bank_mask:0xf
    s_nop 1
    v_add_f32_dpp v13, v13, v13 row_ror:4 row_mask:0xf bank_mask:0xf
    s_nop 1
    v_add_f32_dpp v13, v13, v13 row_ror:2 row_mask:0xf bank_mask:0xf
    s_nop 1
    v_add_f32_dpp v13, v13, v13 row_ror:1 row_mask:0xf bank_mask:0xf
    v_rcp_f32 v13, v13
    s_nop 0
    v_mul_f32 v24, v24, v13
    v_mul_f32 v25, v25, v13
    v_mul_f32 v26, v26, v13
    v_mul_f32 v27, v27, v13
    v_cvt_pk_bf16_f32 v20, v24, v25
    v_cvt_pk_bf16_f32 v21, v26, v27
    ds_write_b16 v42, v20 offset:1280
    ds_write_b16_d16_hi v42, v20 offset:1288
    ds_write_b16 v42, v21 offset:1344
    ds_write_b16_d16_hi v42, v21 offset:1352
    v_mov_b32 v1, 1
    s_lshl_b32 s24, s21, 2
    v_mov_b32 v2, s24
    s_mov_b64 exec, 1
    ds_write_b32 v2, v1 offset:16
    s_endpgm
L_V2:
    s_nop 4
    s_mov_b32 s70, 0x05040100
    s_mov_b32 s71, 0x07060302
    s_mov_b32 s72, 0x7060500
    s_mov_b32 s73, 0x7060501
    s_mov_b32 s74, 0x7060502
    s_mov_b32 s75, 0x7060503
    s_mov_b32 s88, 0xffff0000
    s_mov_b32 s89, 0x3fb8aa3b
    s_mov_b32 s80, 0x20000
    s_waitcnt lgkmcnt(0)
    s_load_dword s60, s[58:59], 0
    s_lshl_b32 s24, s19, 3
    s_add_u32 s24, s24, s16
    s_lshl_b32 s24, s24, 21
    s_lshl_b32 s25, s20, 16
    s_add_u32 s24, s24, s25
    s_lshl_b32 s25, s21, 14
    s_add_u32 s24, s24, s25
    s_mov_b32 s8, s36
    s_mov_b32 s9, s37
    s_add_u32 s8, s8, s24
    s_addc_u32 s9, s9, 0
    s_add_u32 s8, s8, 1572864
    s_addc_u32 s9, s9, 0
    s_and_b32 s9, s9, 0xffff
    s_mov_b32 s10, 16384
    s_mov_b32 s11, 0x00020000
    s_mov_b32 s4, s58
    s_mov_b32 s5, s59
    s_and_b32 s5, s5, 0xffff
    s_mov_b32 s6, 268435456
    s_mov_b32 s7, 0x00020000
    s_cmp_eq_u32 s21, 0
    s_cbranch_scc0 nox_87
    s_waitcnt lgkmcnt(0)
    s_add_u32 s18, s60, 0x9E3779B9
    s_mov_b32 s76, s18
    s_lshr_b32 s77, s18, 8
    s_lshr_b32 s78, s18, 16
    s_lshr_b32 s79, s18, 24
    s_getreg_b32 s63, hwreg(HW_REG_XCC_ID, 0, 4)
    v_mov_b32 v8, s63
    v_mov_b32 v9, 0
    v_mov_b32 v10, 0
    v_mov_b32 v11, s18
    s_lshl_b32 s25, s16, 12
    s_lshl_b32 s24, s17, 7
    s_add_u32 s24, s24, s25
    s_add_u32 s24, s24, 32768
    v_mov_b32 v12, 0
    s_mov_b64 exec, 1
    buffer_store_dwordx4 v[8:11], v12, s[4:7], s24 offen
    s_mov_b64 exec, -1
nox_87:
    v_and_b32 v1, 3, v0
    v_lshlrev_b32 v1, 9, v1
    v_lshrrev_b32 v2, 4, v0
    v_lshlrev_b32 v2, 4, v2
    v_add_u32 v1, v1, v2
    s_lshl_b32 s24, s21, 7
    v_add_u32 v12, s24, v1
    v_and_b32 v1, 15, v0
    v_lshlrev_b32 v1, 9, v1
    v_lshrrev_b32 v2, 4, v0
    v_lshlrev_b32 v2, 7, v2
    v_add_u32 v1, v1, v2
    s_lshl_b32 s24, s21, 11
    v_add_u32 v13, s24, v1
    s_lshl_b32 s26, s21, 2
    v_mov_b32 v14, 0
spin_88:
    ds_read_b32 v15, v14 offset:88
    s_waitcnt lgkmcnt(0)
    v_readfirstlane_b32 s24, v15
    s_nop 0
    s_cmp_ge_u32 s24, 4
    s_cbranch_scc1 spun_89
    s_cmp_eq_u32 s80, 0
    s_cbranch_scc1 spun_89
    s_sub_u32 s80, s80, 1
    s_sleep 2
    s_branch spin_88
spun_89:
    s_sub_u32 s85, s17, 4
    s_cmp_lt_u32 s85, 8
    s_cbranch_scc1 v3_90
    s_cmp_lt_u32 s16, 4
    s_cselect_b32 s25, 4, 12
    s_sub_u32 s24, s17, 12
    s_cmp_lt_u32 s24, s25
    s_cselect_b32 s25, 1, 0
    s_cmp_lt_u32 s17, 4
    s_cselect_b32 s25, 1, s25
    s_cmp_eq_u32 s25, 1
    s_cbranch_scc1 v5_92
    buffer_load_dwordx4 v[32:35], v3, s[8:11], s27 offen nt
    s_add_u32 s27, s27, 1024
    s_and_b32 s27, s27, 0x3fff
    buffer_load_dwordx4 v[36:39], v3, s[8:11], s27 offen nt
    s_add_u32 s27, s27, 1024
    s_and_b32 s27, s27, 0x3fff
    buffer_load_dwordx4 v[40:43], v3, s[8:11], s27 offen nt
    s_add_u32 s27, s27, 1024
    s_and_b32 s27, s27, 0x3fff
    buffer_load_dwordx4 v[44:47], v3, s[8:11], s27 offen nt
    s_add_u32 s27, s27, 1024
    s_and_b32 s27, s27, 0x3fff
    buffer_load_dwordx4 v[48:51], v3, s[8:11], s27 offen nt
    s_add_u32 s27, s27, 1024
    s_and_b32 s27, s27, 0x3fff
    s_waitcnt vmcnt(4)
    buffer_load_dwordx4 v[52:55], v3, s[8:11], s27 offen nt
    s_add_u32 s27, s27, 1024
    s_and_b32 s27, s27, 0x3fff
    s_waitcnt vmcnt(4)
    buffer_load_dwordx4 v[56:59], v3, s[8:11], s27 offen nt
    s_add_u32 s27, s27, 1024
    s_and_b32 s27, s27, 0x3fff
    s_waitcnt vmcnt(4)
    buffer_load_dwordx4 v[60:63], v3, s[8:11], s27 offen nt
    s_add_u32 s27, s27, 1024
    s_and_b32 s27, s27, 0x3fff
    s_waitcnt vmcnt(4)
    buffer_load_dwordx4 v[64:67], v3, s[8:11], s27 offen nt
    s_add_u32 s27, s27, 1024
    s_and_b32 s27, s27, 0x3fff
    s_waitcnt vmcnt(4)
    buffer_load_dwordx4 v[68:71], v3, s[8:11], s27 offen nt
    s_add_u32 s27, s27, 1024
    s_and_b32 s27, s27, 0x3fff
    s_waitcnt vmcnt(4)
    buffer_load_dwordx4 v[72:75], v3, s[8:11], s27 offen nt
    s_add_u32 s27, s27, 1024
    s_and_b32 s27, s27, 0x3fff
    s_waitcnt vmcnt(4)
    buffer_load_dwordx4 v[76:79], v3, s[8:11], s27 offen nt
    s_add_u32 s27, s27, 1024
    s_and_b32 s27, s27, 0x3fff
    s_waitcnt vmcnt(4)
    buffer_load_dwordx4 v[80:83], v3, s[8:11], s27 offen nt
    s_add_u32 s27, s27, 1024
    s_and_b32 s27, s27, 0x3fff
    s_waitcnt vmcnt(4)
    buffer_load_dwordx4 v[84:87], v3, s[8:11], s27 offen nt
    s_add_u32 s27, s27, 1024
    s_and_b32 s27, s27, 0x3fff
    s_waitcnt vmcnt(4)
    buffer_load_dwordx4 v[88:91], v3, s[8:11], s27 offen nt
    s_add_u32 s27, s27, 1024
    s_and_b32 s27, s27, 0x3fff
    s_waitcnt vmcnt(4)
    buffer_load_dwordx4 v[92:95], v3, s[8:11], s27 offen nt
    s_branch v4_91
v5_92:
    buffer_load_dwordx4 v[32:35], v3, s[8:11], s27 offen nt
    s_add_u32 s27, s27, 1024
    s_and_b32 s27, s27, 0x3fff
    buffer_load_dwordx4 v[36:39], v3, s[8:11], s27 offen nt
    s_add_u32 s27, s27, 1024
    s_and_b32 s27, s27, 0x3fff
    buffer_load_dwordx4 v[40:43], v3, s[8:11], s27 offen nt
    s_add_u32 s27, s27, 1024
    s_and_b32 s27, s27, 0x3fff
    buffer_load_dwordx4 v[44:47], v3, s[8:11], s27 offen nt
    s_add_u32 s27, s27, 1024
    s_and_b32 s27, s27, 0x3fff
    buffer_load_dwordx4 v[48:51], v3, s[8:11], s27 offen nt
    s_add_u32 s27, s27, 1024
    s_and_b32 s27, s27, 0x3fff
    buffer_load_dwordx4 v[52:55], v3, s[8:11], s27 offen nt
    s_add_u32 s27, s27, 1024
    s_and_b32 s27, s27, 0x3fff
    buffer_load_dwordx4 v[56:59], v3, s[8:11], s27 offen nt
    s_add_u32 s27, s27, 1024
    s_and_b32 s27, s27, 0x3fff
    buffer_load_dwordx4 v[60:63], v3, s[8:11], s27 offen nt
    s_add_u32 s27, s27, 1024
    s_and_b32 s27, s27, 0x3fff
    s_waitcnt vmcnt(7)
    buffer_load_dwordx4 v[64:67], v3, s[8:11], s27 offen nt
    s_add_u32 s27, s27, 1024
    s_and_b32 s27, s27, 0x3fff
    s_waitcnt vmcnt(7)
    buffer_load_dwordx4 v[68:71], v3, s[8:11], s27 offen nt
    s_add_u32 s27, s27, 1024
    s_and_b32 s27, s27, 0x3fff
    s_waitcnt vmcnt(7)
    buffer_load_dwordx4 v[72:75], v3, s[8:11], s27 offen nt
    s_add_u32 s27, s27, 1024
    s_and_b32 s27, s27, 0x3fff
    s_waitcnt vmcnt(7)
    buffer_load_dwordx4 v[76:79], v3, s[8:11], s27 offen nt
    s_add_u32 s27, s27, 1024
    s_and_b32 s27, s27, 0x3fff
    s_waitcnt vmcnt(7)
    buffer_load_dwordx4 v[80:83], v3, s[8:11], s27 offen nt
    s_add_u32 s27, s27, 1024
    s_and_b32 s27, s27, 0x3fff
    s_waitcnt vmcnt(7)
    buffer_load_dwordx4 v[84:87], v3, s[8:11], s27 offen nt
    s_add_u32 s27, s27, 1024
    s_and_b32 s27, s27, 0x3fff
    s_waitcnt vmcnt(7)
    buffer_load_dwordx4 v[88:91], v3, s[8:11], s27 offen nt
    s_add_u32 s27, s27, 1024
    s_and_b32 s27, s27, 0x3fff
    s_waitcnt vmcnt(7)
    buffer_load_dwordx4 v[92:95], v3, s[8:11], s27 offen nt
    s_branch v4_91
v3_90:
    buffer_load_dwordx4 v[32:35], v3, s[8:11], s27 offen nt
    s_add_u32 s27, s27, 1024
    s_and_b32 s27, s27, 0x3fff
    buffer_load_dwordx4 v[36:39], v3, s[8:11], s27 offen nt
    s_add_u32 s27, s27, 1024
    s_and_b32 s27, s27, 0x3fff
    buffer_load_dwordx4 v[40:43], v3, s[8:11], s27 offen nt
    s_add_u32 s27, s27, 1024
    s_and_b32 s27, s27, 0x3fff
    buffer_load_dwordx4 v[44:47], v3, s[8:11], s27 offen nt
    s_add_u32 s27, s27, 1024
    s_and_b32 s27, s27, 0x3fff
    buffer_load_dwordx4 v[48:51], v3, s[8:11], s27 offen nt
    s_add_u32 s27, s27, 1024
    s_and_b32 s27, s27, 0x3fff
    buffer_load_dwordx4 v[52:55], v3, s[8:11], s27 offen nt
    s_add_u32 s27, s27, 1024
    s_and_b32 s27, s27, 0x3fff
    buffer_load_dwordx4 v[56:59], v3, s[8:11], s27 offen nt
    s_add_u32 s27, s27, 1024
    s_and_b32 s27, s27, 0x3fff
    buffer_load_dwordx4 v[60:63], v3, s[8:11], s27 offen nt
    s_add_u32 s27, s27, 1024
    s_and_b32 s27, s27, 0x3fff
    s_waitcnt vmcnt(7)
    buffer_load_dwordx4 v[64:67], v3, s[8:11], s27 offen nt
    s_add_u32 s27, s27, 1024
    s_and_b32 s27, s27, 0x3fff
    s_waitcnt vmcnt(7)
    buffer_load_dwordx4 v[68:71], v3, s[8:11], s27 offen nt
    s_add_u32 s27, s27, 1024
    s_and_b32 s27, s27, 0x3fff
    s_waitcnt vmcnt(7)
    buffer_load_dwordx4 v[72:75], v3, s[8:11], s27 offen nt
    s_add_u32 s27, s27, 1024
    s_and_b32 s27, s27, 0x3fff
    s_waitcnt vmcnt(7)
    buffer_load_dwordx4 v[76:79], v3, s[8:11], s27 offen nt
    s_add_u32 s27, s27, 1024
    s_and_b32 s27, s27, 0x3fff
    s_waitcnt vmcnt(7)
    buffer_load_dwordx4 v[80:83], v3, s[8:11], s27 offen nt
    s_add_u32 s27, s27, 1024
    s_and_b32 s27, s27, 0x3fff
    s_waitcnt vmcnt(7)
    buffer_load_dwordx4 v[84:87], v3, s[8:11], s27 offen nt
    s_add_u32 s27, s27, 1024
    s_and_b32 s27, s27, 0x3fff
    s_waitcnt vmcnt(7)
    buffer_load_dwordx4 v[88:91], v3, s[8:11], s27 offen nt
    s_add_u32 s27, s27, 1024
    s_and_b32 s27, s27, 0x3fff
    s_waitcnt vmcnt(7)
    buffer_load_dwordx4 v[92:95], v3, s[8:11], s27 offen nt
v4_91:
    v_mov_b32 v1, 0
    v_mov_b32 v2, 1
    s_mov_b64 s[86:87], exec
    s_mov_b64 exec, 1
    ds_add_u32 v1, v2 offset:40
    s_mov_b64 exec, s[86:87]
    s_waitcnt vmcnt(8)
    v_perm_b32 v96, v36, v32, s70
    v_perm_b32 v100, v36, v32, s71
    v_perm_b32 v97, v44, v40, s70
    v_perm_b32 v101, v44, v40, s71
    v_perm_b32 v98, v52, v48, s70
    v_perm_b32 v102, v52, v48, s71
    v_perm_b32 v99, v60, v56, s70
    v_perm_b32 v103, v60, v56, s71
    v_perm_b32 v104, v37, v33, s70
    v_perm_b32 v108, v37, v33, s71
    v_perm_b32 v105, v45, v41, s70
    v_perm_b32 v109, v45, v41, s71
    v_perm_b32 v106, v53, v49, s70
    v_perm_b32 v110, v53, v49, s71
    v_perm_b32 v107, v61, v57, s70
    v_perm_b32 v111, v61, v57, s71
    v_perm_b32 v112, v38, v34, s70
    v_perm_b32 v116, v38, v34, s71
    v_perm_b32 v113, v46, v42, s70
    v_perm_b32 v117, v46, v42, s71
    v_perm_b32 v114, v54, v50, s70
    v_perm_b32 v118, v54, v50, s71
    v_perm_b32 v115, v62, v58, s70
    v_perm_b32 v119, v62, v58, s71
    v_perm_b32 v120, v39, v35, s70
    v_perm_b32 v124, v39, v35, s71
    v_perm_b32 v121, v47, v43, s70
    v_perm_b32 v125, v47, v43, s71
    v_perm_b32 v122, v55, v51, s70
    v_perm_b32 v126, v55, v51, s71
    v_perm_b32 v123, v63, v59, s70
    v_perm_b32 v127, v63, v59, s71
    s_waitcnt vmcnt(0)
    v_perm_b32 v32, v68, v64, s70
    v_perm_b32 v36, v68, v64, s71
    v_perm_b32 v33, v76, v72, s70
    v_perm_b32 v37, v76, v72, s71
    v_perm_b32 v34, v84, v80, s70
    v_perm_b32 v38, v84, v80, s71
    v_perm_b32 v35, v92, v88, s70
    v_perm_b32 v39, v92, v88, s71
    v_perm_b32 v40, v69, v65, s70
    v_perm_b32 v44, v69, v65, s71
    v_perm_b32 v41, v77, v73, s70
    v_perm_b32 v45, v77, v73, s71
    v_perm_b32 v42, v85, v81, s70
    v_perm_b32 v46, v85, v81, s71
    v_perm_b32 v43, v93, v89, s70
    v_perm_b32 v47, v93, v89, s71
    v_perm_b32 v48, v70, v66, s70
    v_perm_b32 v52, v70, v66, s71
    v_perm_b32 v49, v78, v74, s70
    v_perm_b32 v53, v78, v74, s71
    v_perm_b32 v50, v86, v82, s70
    v_perm_b32 v54, v86, v82, s71
    v_perm_b32 v51, v94, v90, s70
    v_perm_b32 v55, v94, v90, s71
    v_perm_b32 v56, v71, v67, s70
    v_perm_b32 v60, v71, v67, s71
    v_perm_b32 v57, v79, v75, s70
    v_perm_b32 v61, v79, v75, s71
    v_perm_b32 v58, v87, v83, s70
    v_perm_b32 v62, v87, v83, s71
    v_perm_b32 v59, v95, v91, s70
    v_perm_b32 v63, v95, v91, s71
    v_mov_b32 v1, s26
pspin_93:
    ds_read_b32 v2, v1 offset:16
    ds_read_b128 v[4:7], v12 offset:1280
    ds_read_b128 v[8:11], v12 offset:1344
    s_waitcnt lgkmcnt(0)
    v_readfirstlane_b32 s24, v2
    s_nop 0
    s_cmp_ge_u32 s24, 1
    s_cbranch_scc1 pspun_94
    s_cmp_eq_u32 s80, 0
    s_cbranch_scc1 pspun_94
    s_sub_u32 s80, s80, 1
    s_branch pspin_93
pspun_94:
    v_mfma_f32_16x16x32_bf16 v[128:131], v[96:99], v[4:7], 0
    v_mfma_f32_16x16x32_bf16 v[132:135], v[100:103], v[4:7], 0
    v_mfma_f32_16x16x32_bf16 v[136:139], v[104:107], v[4:7], 0
    v_mfma_f32_16x16x32_bf16 v[140:143], v[108:111], v[4:7], 0
    v_mfma_f32_16x16x32_bf16 v[144:147], v[112:115], v[4:7], 0
    v_mfma_f32_16x16x32_bf16 v[148:151], v[116:119], v[4:7], 0
    v_mfma_f32_16x16x32_bf16 v[152:155], v[120:123], v[4:7], 0
    v_mfma_f32_16x16x32_bf16 v[156:159], v[124:127], v[4:7], 0
    v_mfma_f32_16x16x32_bf16 v[128:131], v[32:35], v[8:11], v[128:131]
    v_mfma_f32_16x16x32_bf16 v[132:135], v[36:39], v[8:11], v[132:135]
    v_mfma_f32_16x16x32_bf16 v[136:139], v[40:43], v[8:11], v[136:139]
    v_mfma_f32_16x16x32_bf16 v[140:143], v[44:47], v[8:11], v[140:143]
    v_mfma_f32_16x16x32_bf16 v[144:147], v[48:51], v[8:11], v[144:147]
    v_mfma_f32_16x16x32_bf16 v[148:151], v[52:55], v[8:11], v[148:151]
    v_mfma_f32_16x16x32_bf16 v[152:155], v[56:59], v[8:11], v[152:155]
    v_mfma_f32_16x16x32_bf16 v[156:159], v[60:63], v[8:11], v[156:159]
    s_mov_b32 exec_lo, 0x000f000f
    s_mov_b32 exec_hi, 0x000f000f
    ds_write_b128 v13, v[128:131] offset:7424
    ds_write_b128 v13, v[132:135] offset:7440
    ds_write_b128 v13, v[136:139] offset:7456
    ds_write_b128 v13, v[140:143] offset:7472
    ds_write_b128 v13, v[144:147] offset:7488
    ds_write_b128 v13, v[148:151] offset:7504
    ds_write_b128 v13, v[152:155] offset:7520
    ds_write_b128 v13, v[156:159] offset:7536
    s_mov_b64 exec, -1
    v_mov_b32 v1, 0
    v_mov_b32 v2, 1
    s_mov_b64 s[86:87], exec
    s_mov_b64 exec, 1
    ds_add_u32 v1, v2 offset:56
    s_mov_b64 exec, s[86:87]
    s_cmp_eq_u32 s21, 0
    s_cbranch_scc0 vend_95
    s_waitcnt lgkmcnt(0)
    s_add_u32 s18, s60, 0x9E3779B9
    s_mov_b32 s76, s18
    s_lshr_b32 s77, s18, 8
    s_lshr_b32 s78, s18, 16
    s_lshr_b32 s79, s18, 24
    v_lshlrev_b32 v13, 4, v0
    s_mul_i32 s28, s16, 98304
    s_mul_i32 s24, s19, 24576
    s_add_u32 s28, s28, s24
    s_add_u32 s28, s28, 589824
    s_add_u32 s61, s28, 3072
    s_add_u32 s62, s28, 6144
    s_add_u32 s63, s28, 9216
    s_add_u32 s64, s28, 12288
    s_add_u32 s65, s28, 15360
    s_add_u32 s66, s28, 18432
    s_add_u32 s67, s28, 21504
    v_mov_b32 v14, 0
spin_96:
    ds_read_b32 v15, v14 offset:92
    s_waitcnt lgkmcnt(0)
    v_readfirstlane_b32 s24, v15
    s_nop 0
    s_cmp_ge_u32 s24, 1
    s_cbranch_scc1 spun_97
    s_cmp_eq_u32 s80, 0
    s_cbranch_scc1 spun_97
    s_sub_u32 s80, s80, 1
    s_branch spin_96
spun_97:
poll_98:
    buffer_load_dwordx4 v[32:35], v13, s[4:7], s28 offen offset:0 sc1
    buffer_load_dwordx4 v[36:39], v13, s[4:7], s28 offen offset:1024 sc1
    buffer_load_dwordx4 v[40:43], v13, s[4:7], s28 offen offset:2048 sc1
    buffer_load_dwordx4 v[44:47], v13, s[4:7], s61 offen offset:0 sc1
    buffer_load_dwordx4 v[48:51], v13, s[4:7], s61 offen offset:1024 sc1
    buffer_load_dwordx4 v[52:55], v13, s[4:7], s61 offen offset:2048 sc1
    buffer_load_dwordx4 v[56:59], v13, s[4:7], s62 offen offset:0 sc1
    buffer_load_dwordx4 v[60:63], v13, s[4:7], s62 offen offset:1024 sc1
    buffer_load_dwordx4 v[64:67], v13, s[4:7], s62 offen offset:2048 sc1
    buffer_load_dwordx4 v[68:71], v13, s[4:7], s63 offen offset:0 sc1
    buffer_load_dwordx4 v[72:75], v13, s[4:7], s63 offen offset:1024 sc1
    buffer_load_dwordx4 v[76:79], v13, s[4:7], s63 offen offset:2048 sc1
    buffer_load_dwordx4 v[80:83], v13, s[4:7], s64 offen offset:0 sc1
    buffer_load_dwordx4 v[84:87], v13, s[4:7], s64 offen offset:1024 sc1
    buffer_load_dwordx4 v[88:91], v13, s[4:7], s64 offen offset:2048 sc1
    buffer_load_dwordx4 v[92:95], v13, s[4:7], s65 offen offset:0 sc1
    buffer_load_dwordx4 v[96:99], v13, s[4:7], s65 offen offset:1024 sc1
    buffer_load_dwordx4 v[100:103], v13, s[4:7], s65 offen offset:2048 sc1
    buffer_load_dwordx4 v[104:107], v13, s[4:7], s66 offen offset:0 sc1
    buffer_load_dwordx4 v[108:111], v13, s[4:7], s66 offen offset:1024 sc1
    buffer_load_dwordx4 v[112:115], v13, s[4:7], s66 offen offset:2048 sc1
    buffer_load_dwordx4 v[116:119], v13, s[4:7], s67 offen offset:0 sc1
    buffer_load_dwordx4 v[120:123], v13, s[4:7], s67 offen offset:1024 sc1
    buffer_load_dwordx4 v[124:127], v13, s[4:7], s67 offen offset:2048 sc1
    v_mov_b32 v9, 0
    s_waitcnt vmcnt(18)
    v_bitop3_b32 v9, v9, v35, s18 bitop3:0xf6
    v_bitop3_b32 v9, v9, v39, s18 bitop3:0xf6
    v_bitop3_b32 v9, v9, v43, s18 bitop3:0xf6
    v_bitop3_b32 v9, v9, v47, s18 bitop3:0xf6
    v_bitop3_b32 v9, v9, v51, s18 bitop3:0xf6
    v_bitop3_b32 v9, v9, v55, s18 bitop3:0xf6
    v_pk_add_f32 v[128:129], v[32:33], v[44:45]
    v_add_f32 v130, v34, v46
    v_add_f32 v131, v36, v48
    v_add_f32 v132, v37, v49
    v_add_f32 v133, v38, v50
    v_pk_add_f32 v[134:135], v[40:41], v[52:53]
    s_waitcnt vmcnt(12)
    v_bitop3_b32 v9, v9, v59, s18 bitop3:0xf6
    v_bitop3_b32 v9, v9, v63, s18 bitop3:0xf6
    v_bitop3_b32 v9, v9, v67, s18 bitop3:0xf6
    v_bitop3_b32 v9, v9, v71, s18 bitop3:0xf6
    v_bitop3_b32 v9, v9, v75, s18 bitop3:0xf6
    v_bitop3_b32 v9, v9, v79, s18 bitop3:0xf6
    v_pk_add_f32 v[136:137], v[56:57], v[68:69]
    v_add_f32 v138, v58, v70
    v_add_f32 v139, v60, v72
    v_add_f32 v140, v61, v73
    v_add_f32 v141, v62, v74
    v_pk_add_f32 v[142:143], v[64:65], v[76:77]
    s_waitcnt vmcnt(6)
    v_bitop3_b32 v9, v9, v83, s18 bitop3:0xf6
    v_bitop3_b32 v9, v9, v87, s18 bitop3:0xf6
    v_bitop3_b32 v9, v9, v91, s18 bitop3:0xf6
    v_bitop3_b32 v9, v9, v95, s18 bitop3:0xf6
    v_bitop3_b32 v9, v9, v99, s18 bitop3:0xf6
    v_bitop3_b32 v9, v9, v103, s18 bitop3:0xf6
    v_pk_add_f32 v[144:145], v[80:81], v[92:93]
    v_add_f32 v146, v82, v94
    v_add_f32 v147, v84, v96
    v_add_f32 v148, v85, v97
    v_add_f32 v149, v86, v98
    v_pk_add_f32 v[150:151], v[88:89], v[100:101]
    s_waitcnt vmcnt(0)
    v_bitop3_b32 v9, v9, v107, s18 bitop3:0xf6
    v_bitop3_b32 v9, v9, v111, s18 bitop3:0xf6
    v_bitop3_b32 v9, v9, v115, s18 bitop3:0xf6
    v_bitop3_b32 v9, v9, v119, s18 bitop3:0xf6
    v_bitop3_b32 v9, v9, v123, s18 bitop3:0xf6
    v_bitop3_b32 v9, v9, v127, s18 bitop3:0xf6
    v_pk_add_f32 v[152:153], v[104:105], v[116:117]
    v_add_f32 v154, v106, v118
    v_add_f32 v155, v108, v120
    v_add_f32 v156, v109, v121
    v_add_f32 v157, v110, v122
    v_pk_add_f32 v[158:159], v[112:113], v[124:125]
    v_cmp_ne_u32 s[82:83], 0, v9
    s_nop 0
    s_cmp_eq_u64 s[82:83], 0
    s_cbranch_scc1 polled_99
    s_cmp_eq_u32 s80, 0
    s_cbranch_scc1 polled_99
    s_sub_u32 s80, s80, 1
    s_branch poll_98
polled_99:
    v_pk_add_f32 v[128:129], v[128:129], v[136:137]
    v_pk_add_f32 v[130:131], v[130:131], v[138:139]
    v_pk_add_f32 v[132:133], v[132:133], v[140:141]
    v_pk_add_f32 v[134:135], v[134:135], v[142:143]
    v_pk_add_f32 v[144:145], v[144:145], v[152:153]
    v_pk_add_f32 v[146:147], v[146:147], v[154:155]
    v_pk_add_f32 v[148:149], v[148:149], v[156:157]
    v_pk_add_f32 v[150:151], v[150:151], v[158:159]
    v_pk_add_f32 v[128:129], v[128:129], v[144:145]
    v_pk_add_f32 v[130:131], v[130:131], v[146:147]
    v_pk_add_f32 v[132:133], v[132:133], v[148:149]
    v_pk_add_f32 v[134:135], v[134:135], v[150:151]
    v_cvt_pk_bf16_f32 v4, v128, v129
    v_cvt_pk_bf16_f32 v5, v130, v131
    v_cvt_pk_bf16_f32 v6, v132, v133
    v_cvt_pk_bf16_f32 v7, v134, v135
    ds_write_b128 v13, v[4:7] offset:256
    v_mov_b32 v14, 0
    v_mov_b32 v15, 1
    s_mov_b64 s[86:87], exec
    s_mov_b64 exec, 1
    ds_write_b32 v14, v15 offset:96
    s_mov_b64 exec, s[86:87]
vend_95:
    s_endpgm
L_END:
    s_endpgm
.section .rodata,"a"
.p2align 6
.amdhsa_kernel adaLN_cond__sliding_block_cached__swiglu_ffn__decode_kernel
  .amdhsa_next_free_vgpr 168
  .amdhsa_next_free_sgpr 102
  .amdhsa_accum_offset 168
  .amdhsa_group_segment_fixed_size 0
  .amdhsa_kernarg_size 112
  .amdhsa_user_sgpr_count 2
  .amdhsa_user_sgpr_kernarg_segment_ptr 1
  .amdhsa_system_sgpr_workgroup_id_x 1
  .amdhsa_float_denorm_mode_32 3
.end_amdhsa_kernel
```
